```python
import torch

def _softmax(x, axis=-1):
    return torch.softmax(x, dim=axis)
def _gelu(x):
    return torch.nn.functional.gelu(x, approximate="tanh")
def _silu(x):
    return torch.nn.functional.silu(x)
def _sigmoid(x):
    return torch.sigmoid(x)
def _layernorm(x, axis=-1, eps=1e-5):
    m = x.mean(dim=axis, keepdim=True)
    v = x.var(dim=axis, keepdim=True, unbiased=False)
    return (x - m) / torch.sqrt(v + eps)
def _scatter_add(tgt, idx, src, axis=0):
    return tgt.clone().index_add_(axis, idx, src)
def _segment_sum(src, seg, n):
    out = torch.zeros((n,) + src.shape[1:], dtype=src.dtype)
    return out.index_add_(0, seg, src)
def _pad(x, pw):
    flat = tuple(v for pair in reversed(pw) for v in pair)
    return torch.nn.functional.pad(x, flat)

kernel_name = 'standalone__low_rank_proj_linformer__decode'

def setup_inputs():

    _w = (lambda a: (lambda t: t.to(torch.bfloat16) if t.is_floating_point() else t)(torch.as_tensor(a)))
    B, H, Sq, Skv, Dh, R = 2, 32, 1, 16384, 128, 64
    return {
        "q": _w((lambda *s: torch.randn(*s, dtype=torch.bfloat16) * 0.8)(B, H, Sq, Dh)),
        "k": _w((lambda *s: torch.randn(*s, dtype=torch.bfloat16) * 0.8)(B, H, Skv, Dh)),
        "v": _w((lambda *s: torch.randn(*s, dtype=torch.bfloat16) * 0.05)(B, H, Skv, Dh)),
        "e_proj": _w((lambda *s: torch.randn(*s, dtype=torch.bfloat16) * 0.8)(R, Skv) * (Skv ** -0.5)),
        "f_proj": _w((lambda *s: torch.randn(*s, dtype=torch.bfloat16) * 0.05)(R, Skv) * (Skv ** -0.5)),
    }

def reference(q, k, v, e_proj, f_proj):
    B, H, Sq, Dh = q.shape
    kp = torch.einsum("rn,bhnd->bhrd", e_proj, k)
    vp = torch.einsum("rn,bhnd->bhrd", f_proj, v)
    scores = torch.einsum("bhqd,bhrd->bhqr", q, kp) * (Dh ** -0.5)
    p = _softmax(scores, axis=-1)
    o = torch.einsum("bhqr,bhrd->bhqd", p, vp)
    return o
```

```asm
; @launch grid=(256,1,1) block=(512,1,1) lds=161280
.amdgcn_target "amdgcn-amd-amdhsa--gfx950"
.text
.globl standalone__low_rank_proj_linformer__decode_kernel
.p2align 8
.type standalone__low_rank_proj_linformer__decode_kernel,@function
standalone__low_rank_proj_linformer__decode_kernel:
s_cmp_ge_u32 s2, 256
s_cbranch_scc1 L_done
s_load_dwordx16 s[4:19], s[0:1], 0
v_lshrrev_b32 v1, 6, v0
v_and_b32 v0, 63, v0
v_readfirstlane_b32 s3, v1
s_and_b32 s20, s2, 15
s_lshr_b32 s21, s2, 4
s_and_b32 s69, s21, 3
v_lshrrev_b32 v4, 4, v0
v_and_b32 v5, 15, v0
v_mov_b32 v6, 160256
v_mov_b32 v7, 1
v_lshlrev_b32 v2, 4, v0
s_cmp_ge_u32 s3, 4
s_cbranch_scc1 L_helper
v_add_u32 v137, 4096, v2
v_add_u32 v138, 8192, v2
v_add_u32 v139, 12288, v2
v_add_u32 v140, 16384, v2
v_add_u32 v141, 20480, v2
v_add_u32 v142, 24576, v2
v_add_u32 v143, 28672, v2
v_lshlrev_b32 v8, 4, v5
s_lshl_b32 s36, s21, 24
s_bfe_u32 s37, s20, 196608
s_lshl_b32 s37, s37, 16
s_add_u32 s36, s36, s37
s_bfe_u32 s37, s20, 65539
s_lshl_b32 s37, s37, 21
s_add_u32 s36, s36, s37
s_bfe_u32 s37, s3, 65536
s_lshl_b32 s37, s37, 11
s_add_u32 s36, s36, s37
s_bfe_u32 s37, s3, 65537
s_lshl_b32 s37, s37, 10
s_add_u32 s36, s36, s37
s_lshl_b32 s50, s69, 22
s_add_u32 s50, s50, s36
s_lshl_b32 s39, s21, 10
s_xor_b32 s52, s69, 0
s_lshl_b32 s52, s52, 8
s_add_u32 s52, s52, s39
s_xor_b32 s53, s69, 1
s_lshl_b32 s53, s53, 8
s_add_u32 s53, s53, s39
s_xor_b32 s54, s69, 2
s_lshl_b32 s54, s54, 8
s_add_u32 s54, s54, s39
s_xor_b32 s55, s69, 3
s_lshl_b32 s55, s55, 8
s_add_u32 s55, s55, s39
s_waitcnt lgkmcnt(0)
s_mov_b32 s24, s6
s_mov_b32 s25, s7
s_mov_b32 s26, 0x10000000
s_mov_b32 s27, 0x20000
s_mov_b32 s32, s4
s_mov_b32 s33, s5
s_mov_b32 s34, 16384
s_mov_b32 s35, 0x20000
buffer_load_dwordx4 v[48:51], v8, s[32:35], s52 offen
buffer_load_dwordx4 v[52:55], v8, s[32:35], s53 offen
buffer_load_dwordx4 v[56:59], v8, s[32:35], s54 offen
buffer_load_dwordx4 v[60:63], v8, s[32:35], s55 offen
buffer_load_dwordx4 v[16:19], v2, s[24:27], s50 offen offset:0 nt
buffer_load_dwordx4 v[20:23], v138, s[24:27], s50 offen offset:0 nt
buffer_load_dwordx4 v[24:27], v137, s[24:27], s50 offen offset:0 nt
buffer_load_dwordx4 v[28:31], v139, s[24:27], s50 offen offset:0 nt
buffer_load_dwordx4 v[32:35], v140, s[24:27], s50 offen offset:0 nt
s_mov_b32 s28, s8
s_mov_b32 s29, s9
s_mov_b32 s30, 0x10000000
s_mov_b32 s31, 0x20000
v_and_b32 v9, 1, v0
v_sub_u32 v10, 0, v9
v_and_b32 v76, 0xffff0000, v10
v_mul_u32_u24 v77, 2112, v9
s_bfe_u32 s37, s3, 65536
s_lshl_b32 s37, s37, 3
s_bfe_u32 s43, s3, 65537
s_lshl_b32 s43, s43, 2
s_add_u32 s37, s37, s43
v_bfe_u32 v11, v0, 2, 1
v_lshl_add_u32 v10, v11, 5, v4
v_bfe_u32 v11, v0, 3, 1
v_lshl_add_u32 v10, v11, 4, v10
v_add_u32 v10, s37, v10
v_lshl_add_u32 v77, v10, 1, v77
v_add_u32 v77, 132096, v77
v_bfe_u32 v11, v0, 0, 1
v_lshl_add_u32 v10, v11, 5, v4
v_bfe_u32 v11, v0, 1, 1
v_lshl_add_u32 v10, v11, 4, v10
v_bfe_u32 v11, v0, 2, 1
v_lshl_add_u32 v10, v11, 6, v10
v_lshlrev_b32 v98, 2, v10
v_add_u32 v10, s37, v10
v_lshlrev_b32 v78, 2, v10
v_add_u32 v78, 132096, v78
v_lshlrev_b32 v10, 5, v5
v_lshl_add_u32 v10, v4, 3, v10
s_lshl_b32 s37, s3, 9
v_add_u32 v10, s37, v10
v_add_u32 v96, 148992, v10
v_mov_b32 v80, 0
v_mov_b32 v81, 0
v_mov_b32 v82, 0
v_mov_b32 v83, 0
v_mov_b32 v84, 0
v_mov_b32 v85, 0
v_mov_b32 v86, 0
v_mov_b32 v87, 0
v_mov_b32 v97, v6
s_cmp_eq_u32 s3, 0
s_cselect_b32 s48, 1, 0
s_mov_b32 s40, 0xffff0000
s_barrier
s_mov_b32 s38, 0
s_mov_b32 s41, s50
L_kloop:
s_add_u32 s43, s38, 1
s_lshr_b32 s44, s43, 3
s_and_b32 s43, s43, 7
s_xor_b32 s44, s44, s69
s_lshl_b32 s44, s44, 22
s_add_u32 s42, s36, s44
s_bfe_u32 s44, s43, 65536
s_lshl_b32 s44, s44, 15
s_add_u32 s42, s42, s44
s_bfe_u32 s44, s43, 131073
s_lshl_b32 s44, s44, 19
s_add_u32 s42, s42, s44
s_waitcnt vmcnt(4)
buffer_load_dwordx4 v[36:39], v142, s[24:27], s41 offen offset:0 nt
v_dot2_f32_bf16 v64, v16, v48, 0
v_dot2_f32_bf16 v64, v17, v49, v64
v_dot2_f32_bf16 v64, v18, v50, v64
v_dot2_f32_bf16 v64, v19, v51, v64
s_waitcnt vmcnt(4)
buffer_load_dwordx4 v[40:43], v141, s[24:27], s41 offen offset:0 nt
v_dot2_f32_bf16 v65, v20, v48, 0
v_dot2_f32_bf16 v65, v21, v49, v65
v_dot2_f32_bf16 v65, v22, v50, v65
v_dot2_f32_bf16 v65, v23, v51, v65
s_waitcnt vmcnt(4)
buffer_load_dwordx4 v[44:47], v143, s[24:27], s41 offen offset:0 nt
v_dot2_f32_bf16 v66, v24, v48, 0
v_dot2_f32_bf16 v66, v25, v49, v66
v_dot2_f32_bf16 v66, v26, v50, v66
v_dot2_f32_bf16 v66, v27, v51, v66
s_waitcnt vmcnt(4)
buffer_load_dwordx4 v[16:19], v2, s[24:27], s42 offen offset:0 nt
v_dot2_f32_bf16 v67, v28, v48, 0
v_dot2_f32_bf16 v67, v29, v49, v67
v_dot2_f32_bf16 v67, v30, v50, v67
v_dot2_f32_bf16 v67, v31, v51, v67
v_add_f32_dpp v72, v64, v64 row_ror:8 row_mask:0xf bank_mask:0x3
v_add_f32_dpp v73, v65, v65 row_ror:8 row_mask:0xf bank_mask:0x3
s_nop 0
v_add_f32_dpp v72, v66, v66 row_ror:8 row_mask:0xf bank_mask:0xc
v_add_f32_dpp v73, v67, v67 row_ror:8 row_mask:0xf bank_mask:0xc
s_nop 0
v_add_f32_dpp v74, v72, v72 row_half_mirror row_mask:0xf bank_mask:0x5
s_nop 1
v_add_f32_dpp v74, v73, v73 row_half_mirror row_mask:0xf bank_mask:0xa
s_nop 1
v_add_f32_dpp v74, v74, v74 quad_perm:[1,0,3,2] row_mask:0xf bank_mask:0xf
s_nop 1
v_add_f32_dpp v74, v74, v74 quad_perm:[2,3,0,1] row_mask:0xf bank_mask:0xf
v_and_b32 v75, v74, v76
v_sub_f32 v75, v74, v75
ds_write_b16_d16_hi v77, v75 offset:0
s_waitcnt vmcnt(4)
buffer_load_dwordx4 v[20:23], v138, s[24:27], s42 offen offset:0 nt
v_dot2_f32_bf16 v68, v32, v48, 0
v_dot2_f32_bf16 v68, v33, v49, v68
v_dot2_f32_bf16 v68, v34, v50, v68
v_dot2_f32_bf16 v68, v35, v51, v68
s_waitcnt vmcnt(4)
buffer_load_dwordx4 v[24:27], v137, s[24:27], s42 offen offset:0 nt
v_dot2_f32_bf16 v69, v36, v48, 0
v_dot2_f32_bf16 v69, v37, v49, v69
v_dot2_f32_bf16 v69, v38, v50, v69
v_dot2_f32_bf16 v69, v39, v51, v69
s_waitcnt vmcnt(4)
buffer_load_dwordx4 v[28:31], v139, s[24:27], s42 offen offset:0 nt
v_dot2_f32_bf16 v70, v40, v48, 0
v_dot2_f32_bf16 v70, v41, v49, v70
v_dot2_f32_bf16 v70, v42, v50, v70
v_dot2_f32_bf16 v70, v43, v51, v70
s_waitcnt vmcnt(4)
buffer_load_dwordx4 v[32:35], v140, s[24:27], s42 offen offset:0 nt
v_dot2_f32_bf16 v71, v44, v48, 0
v_dot2_f32_bf16 v71, v45, v49, v71
v_dot2_f32_bf16 v71, v46, v50, v71
v_dot2_f32_bf16 v71, v47, v51, v71
v_add_f32_dpp v72, v68, v68 row_ror:8 row_mask:0xf bank_mask:0x3
v_add_f32_dpp v73, v69, v69 row_ror:8 row_mask:0xf bank_mask:0x3
s_nop 0
v_add_f32_dpp v72, v70, v70 row_ror:8 row_mask:0xf bank_mask:0xc
v_add_f32_dpp v73, v71, v71 row_ror:8 row_mask:0xf bank_mask:0xc
s_nop 0
v_add_f32_dpp v74, v72, v72 row_half_mirror row_mask:0xf bank_mask:0x5
s_nop 1
v_add_f32_dpp v74, v73, v73 row_half_mirror row_mask:0xf bank_mask:0xa
s_nop 1
v_add_f32_dpp v74, v74, v74 quad_perm:[1,0,3,2] row_mask:0xf bank_mask:0xf
s_nop 1
v_add_f32_dpp v74, v74, v74 quad_perm:[2,3,0,1] row_mask:0xf bank_mask:0xf
v_and_b32 v75, v74, v76
v_sub_f32 v75, v74, v75
ds_write_b16_d16_hi v77, v75 offset:128
v_add_u32 v77, 256, v77
s_cmp_eq_u32 s48, 0
s_cbranch_scc1 L_nt1
s_mov_b64 exec, 1
ds_add_u32 v6, v7 offset:80
s_mov_b64 exec, -1
L_nt1:
s_mov_b32 s41, s42
s_add_u32 s38, s38, 1
s_and_b32 s43, s38, 7
s_cbranch_scc1 L_knohead
s_mov_b64 exec, 1
ds_add_u32 v97, v7 offset:0
s_mov_b64 exec, -1
v_add_u32 v97, 4, v97
v_add_u32 v77, 2176, v77
v_mov_b32 v48, v52
v_mov_b32 v49, v53
v_mov_b32 v50, v54
v_mov_b32 v51, v55
v_mov_b32 v52, v56
v_mov_b32 v53, v57
v_mov_b32 v54, v58
v_mov_b32 v55, v59
v_mov_b32 v56, v60
v_mov_b32 v57, v61
v_mov_b32 v58, v62
v_mov_b32 v59, v63
L_knohead:
s_cmp_lt_u32 s38, 31
s_cbranch_scc1 L_kloop
s_waitcnt vmcnt(4)
buffer_load_dwordx4 v[36:39], v142, s[24:27], s41 offen offset:0 nt
v_dot2_f32_bf16 v64, v16, v48, 0
v_dot2_f32_bf16 v64, v17, v49, v64
v_dot2_f32_bf16 v64, v18, v50, v64
v_dot2_f32_bf16 v64, v19, v51, v64
s_waitcnt vmcnt(4)
buffer_load_dwordx4 v[40:43], v141, s[24:27], s41 offen offset:0 nt
v_dot2_f32_bf16 v65, v20, v48, 0
v_dot2_f32_bf16 v65, v21, v49, v65
v_dot2_f32_bf16 v65, v22, v50, v65
v_dot2_f32_bf16 v65, v23, v51, v65
s_waitcnt vmcnt(4)
buffer_load_dwordx4 v[44:47], v143, s[24:27], s41 offen offset:0 nt
v_dot2_f32_bf16 v66, v24, v48, 0
v_dot2_f32_bf16 v66, v25, v49, v66
v_dot2_f32_bf16 v66, v26, v50, v66
v_dot2_f32_bf16 v66, v27, v51, v66
s_waitcnt vmcnt(4)
buffer_load_dwordx4 v[16:19], v2, s[28:31], s50 offen offset:0 nt
v_dot2_f32_bf16 v67, v28, v48, 0
v_dot2_f32_bf16 v67, v29, v49, v67
v_dot2_f32_bf16 v67, v30, v50, v67
v_dot2_f32_bf16 v67, v31, v51, v67
v_add_f32_dpp v72, v64, v64 row_ror:8 row_mask:0xf bank_mask:0x3
v_add_f32_dpp v73, v65, v65 row_ror:8 row_mask:0xf bank_mask:0x3
s_nop 0
v_add_f32_dpp v72, v66, v66 row_ror:8 row_mask:0xf bank_mask:0xc
v_add_f32_dpp v73, v67, v67 row_ror:8 row_mask:0xf bank_mask:0xc
s_nop 0
v_add_f32_dpp v74, v72, v72 row_half_mirror row_mask:0xf bank_mask:0x5
s_nop 1
v_add_f32_dpp v74, v73, v73 row_half_mirror row_mask:0xf bank_mask:0xa
s_nop 1
v_add_f32_dpp v74, v74, v74 quad_perm:[1,0,3,2] row_mask:0xf bank_mask:0xf
s_nop 1
v_add_f32_dpp v74, v74, v74 quad_perm:[2,3,0,1] row_mask:0xf bank_mask:0xf
v_and_b32 v75, v74, v76
v_sub_f32 v75, v74, v75
ds_write_b16_d16_hi v77, v75 offset:0
s_waitcnt vmcnt(4)
buffer_load_dwordx4 v[20:23], v138, s[28:31], s50 offen offset:0 nt
v_dot2_f32_bf16 v68, v32, v48, 0
v_dot2_f32_bf16 v68, v33, v49, v68
v_dot2_f32_bf16 v68, v34, v50, v68
v_dot2_f32_bf16 v68, v35, v51, v68
s_waitcnt vmcnt(4)
buffer_load_dwordx4 v[24:27], v137, s[28:31], s50 offen offset:0 nt
v_dot2_f32_bf16 v69, v36, v48, 0
v_dot2_f32_bf16 v69, v37, v49, v69
v_dot2_f32_bf16 v69, v38, v50, v69
v_dot2_f32_bf16 v69, v39, v51, v69
s_waitcnt vmcnt(4)
buffer_load_dwordx4 v[28:31], v139, s[28:31], s50 offen offset:0 nt
v_dot2_f32_bf16 v70, v40, v48, 0
v_dot2_f32_bf16 v70, v41, v49, v70
v_dot2_f32_bf16 v70, v42, v50, v70
v_dot2_f32_bf16 v70, v43, v51, v70
s_waitcnt vmcnt(4)
buffer_load_dwordx4 v[32:35], v140, s[28:31], s50 offen offset:0 nt
buffer_load_dwordx4 v[36:39], v142, s[28:31], s50 offen offset:0 nt
v_dot2_f32_bf16 v71, v44, v48, 0
v_dot2_f32_bf16 v71, v45, v49, v71
v_dot2_f32_bf16 v71, v46, v50, v71
v_dot2_f32_bf16 v71, v47, v51, v71
v_add_f32_dpp v72, v68, v68 row_ror:8 row_mask:0xf bank_mask:0x3
v_add_f32_dpp v73, v69, v69 row_ror:8 row_mask:0xf bank_mask:0x3
s_nop 0
v_add_f32_dpp v72, v70, v70 row_ror:8 row_mask:0xf bank_mask:0xc
v_add_f32_dpp v73, v71, v71 row_ror:8 row_mask:0xf bank_mask:0xc
s_nop 0
v_add_f32_dpp v74, v72, v72 row_half_mirror row_mask:0xf bank_mask:0x5
s_nop 1
v_add_f32_dpp v74, v73, v73 row_half_mirror row_mask:0xf bank_mask:0xa
s_nop 1
v_add_f32_dpp v74, v74, v74 quad_perm:[1,0,3,2] row_mask:0xf bank_mask:0xf
s_nop 1
v_add_f32_dpp v74, v74, v74 quad_perm:[2,3,0,1] row_mask:0xf bank_mask:0xf
v_and_b32 v75, v74, v76
v_sub_f32 v75, v74, v75
ds_write_b16_d16_hi v77, v75 offset:128
v_add_u32 v77, 256, v77
s_cmp_eq_u32 s48, 0
s_cbranch_scc1 L_nt2
s_mov_b64 exec, 1
ds_add_u32 v6, v7 offset:80
s_mov_b64 exec, -1
L_nt2:
s_mov_b64 exec, 1
ds_add_u32 v97, v7 offset:0
s_mov_b64 exec, -1
v_add_u32 v97, 4, v97
s_mov_b32 s38, 0
s_mov_b32 s41, s50
L_vhead:
s_mov_b32 s46, 0x40000
L_w3:
ds_read_b32 v75, v97 offset:48
s_waitcnt lgkmcnt(0)
v_readfirstlane_b32 s43, v75
s_nop 0
s_cmp_ge_u32 s43, 4
s_cbranch_scc1 L_wd4
s_sub_u32 s46, s46, 1
s_cbranch_scc1 L_wd4
s_sleep 2
s_branch L_w3
L_wd4:
L_vloop:
s_add_u32 s43, s38, 1
s_lshr_b32 s44, s43, 3
s_and_b32 s43, s43, 7
s_xor_b32 s44, s44, s69
s_lshl_b32 s44, s44, 22
s_add_u32 s42, s36, s44
s_bfe_u32 s44, s43, 65536
s_lshl_b32 s44, s44, 15
s_add_u32 s42, s42, s44
s_bfe_u32 s44, s43, 131073
s_lshl_b32 s44, s44, 19
s_add_u32 s42, s42, s44
ds_read_b32 v79, v78
s_waitcnt vmcnt(5)
buffer_load_dwordx4 v[40:43], v141, s[28:31], s41 offen offset:0 nt
s_waitcnt lgkmcnt(0)
v_lshlrev_b32 v88, 16, v16
v_and_b32 v89, s40, v16
v_lshlrev_b32 v90, 16, v17
v_and_b32 v91, s40, v17
v_lshlrev_b32 v92, 16, v18
v_and_b32 v93, s40, v18
v_lshlrev_b32 v94, 16, v19
v_and_b32 v95, s40, v19
v_fmac_f32_dpp v80, v79, v88 row_newbcast:0 row_mask:0xf bank_mask:0xf
v_fmac_f32_dpp v81, v79, v89 row_newbcast:0 row_mask:0xf bank_mask:0xf
v_fmac_f32_dpp v82, v79, v90 row_newbcast:0 row_mask:0xf bank_mask:0xf
v_fmac_f32_dpp v83, v79, v91 row_newbcast:0 row_mask:0xf bank_mask:0xf
v_fmac_f32_dpp v84, v79, v92 row_newbcast:0 row_mask:0xf bank_mask:0xf
v_fmac_f32_dpp v85, v79, v93 row_newbcast:0 row_mask:0xf bank_mask:0xf
v_fmac_f32_dpp v86, v79, v94 row_newbcast:0 row_mask:0xf bank_mask:0xf
v_fmac_f32_dpp v87, v79, v95 row_newbcast:0 row_mask:0xf bank_mask:0xf
s_waitcnt vmcnt(5)
buffer_load_dwordx4 v[44:47], v143, s[28:31], s41 offen offset:0 nt
v_lshlrev_b32 v88, 16, v20
v_and_b32 v89, s40, v20
v_lshlrev_b32 v90, 16, v21
v_and_b32 v91, s40, v21
v_lshlrev_b32 v92, 16, v22
v_and_b32 v93, s40, v22
v_lshlrev_b32 v94, 16, v23
v_and_b32 v95, s40, v23
v_fmac_f32_dpp v80, v79, v88 row_newbcast:1 row_mask:0xf bank_mask:0xf
v_fmac_f32_dpp v81, v79, v89 row_newbcast:1 row_mask:0xf bank_mask:0xf
v_fmac_f32_dpp v82, v79, v90 row_newbcast:1 row_mask:0xf bank_mask:0xf
v_fmac_f32_dpp v83, v79, v91 row_newbcast:1 row_mask:0xf bank_mask:0xf
v_fmac_f32_dpp v84, v79, v92 row_newbcast:1 row_mask:0xf bank_mask:0xf
v_fmac_f32_dpp v85, v79, v93 row_newbcast:1 row_mask:0xf bank_mask:0xf
v_fmac_f32_dpp v86, v79, v94 row_newbcast:1 row_mask:0xf bank_mask:0xf
v_fmac_f32_dpp v87, v79, v95 row_newbcast:1 row_mask:0xf bank_mask:0xf
s_waitcnt vmcnt(5)
buffer_load_dwordx4 v[16:19], v2, s[28:31], s42 offen offset:0 nt
v_lshlrev_b32 v88, 16, v24
v_and_b32 v89, s40, v24
v_lshlrev_b32 v90, 16, v25
v_and_b32 v91, s40, v25
v_lshlrev_b32 v92, 16, v26
v_and_b32 v93, s40, v26
v_lshlrev_b32 v94, 16, v27
v_and_b32 v95, s40, v27
v_fmac_f32_dpp v80, v79, v88 row_newbcast:2 row_mask:0xf bank_mask:0xf
v_fmac_f32_dpp v81, v79, v89 row_newbcast:2 row_mask:0xf bank_mask:0xf
v_fmac_f32_dpp v82, v79, v90 row_newbcast:2 row_mask:0xf bank_mask:0xf
v_fmac_f32_dpp v83, v79, v91 row_newbcast:2 row_mask:0xf bank_mask:0xf
v_fmac_f32_dpp v84, v79, v92 row_newbcast:2 row_mask:0xf bank_mask:0xf
v_fmac_f32_dpp v85, v79, v93 row_newbcast:2 row_mask:0xf bank_mask:0xf
v_fmac_f32_dpp v86, v79, v94 row_newbcast:2 row_mask:0xf bank_mask:0xf
v_fmac_f32_dpp v87, v79, v95 row_newbcast:2 row_mask:0xf bank_mask:0xf
s_waitcnt vmcnt(5)
buffer_load_dwordx4 v[20:23], v138, s[28:31], s42 offen offset:0 nt
v_lshlrev_b32 v88, 16, v28
v_and_b32 v89, s40, v28
v_lshlrev_b32 v90, 16, v29
v_and_b32 v91, s40, v29
v_lshlrev_b32 v92, 16, v30
v_and_b32 v93, s40, v30
v_lshlrev_b32 v94, 16, v31
v_and_b32 v95, s40, v31
v_fmac_f32_dpp v80, v79, v88 row_newbcast:3 row_mask:0xf bank_mask:0xf
v_fmac_f32_dpp v81, v79, v89 row_newbcast:3 row_mask:0xf bank_mask:0xf
v_fmac_f32_dpp v82, v79, v90 row_newbcast:3 row_mask:0xf bank_mask:0xf
v_fmac_f32_dpp v83, v79, v91 row_newbcast:3 row_mask:0xf bank_mask:0xf
v_fmac_f32_dpp v84, v79, v92 row_newbcast:3 row_mask:0xf bank_mask:0xf
v_fmac_f32_dpp v85, v79, v93 row_newbcast:3 row_mask:0xf bank_mask:0xf
v_fmac_f32_dpp v86, v79, v94 row_newbcast:3 row_mask:0xf bank_mask:0xf
v_fmac_f32_dpp v87, v79, v95 row_newbcast:3 row_mask:0xf bank_mask:0xf
s_waitcnt vmcnt(5)
buffer_load_dwordx4 v[24:27], v137, s[28:31], s42 offen offset:0 nt
v_lshlrev_b32 v88, 16, v32
v_and_b32 v89, s40, v32
v_lshlrev_b32 v90, 16, v33
v_and_b32 v91, s40, v33
v_lshlrev_b32 v92, 16, v34
v_and_b32 v93, s40, v34
v_lshlrev_b32 v94, 16, v35
v_and_b32 v95, s40, v35
v_fmac_f32_dpp v80, v79, v88 row_newbcast:4 row_mask:0xf bank_mask:0xf
v_fmac_f32_dpp v81, v79, v89 row_newbcast:4 row_mask:0xf bank_mask:0xf
v_fmac_f32_dpp v82, v79, v90 row_newbcast:4 row_mask:0xf bank_mask:0xf
v_fmac_f32_dpp v83, v79, v91 row_newbcast:4 row_mask:0xf bank_mask:0xf
v_fmac_f32_dpp v84, v79, v92 row_newbcast:4 row_mask:0xf bank_mask:0xf
v_fmac_f32_dpp v85, v79, v93 row_newbcast:4 row_mask:0xf bank_mask:0xf
v_fmac_f32_dpp v86, v79, v94 row_newbcast:4 row_mask:0xf bank_mask:0xf
v_fmac_f32_dpp v87, v79, v95 row_newbcast:4 row_mask:0xf bank_mask:0xf
s_waitcnt vmcnt(5)
buffer_load_dwordx4 v[28:31], v139, s[28:31], s42 offen offset:0 nt
v_lshlrev_b32 v88, 16, v36
v_and_b32 v89, s40, v36
v_lshlrev_b32 v90, 16, v37
v_and_b32 v91, s40, v37
v_lshlrev_b32 v92, 16, v38
v_and_b32 v93, s40, v38
v_lshlrev_b32 v94, 16, v39
v_and_b32 v95, s40, v39
v_fmac_f32_dpp v80, v79, v88 row_newbcast:5 row_mask:0xf bank_mask:0xf
v_fmac_f32_dpp v81, v79, v89 row_newbcast:5 row_mask:0xf bank_mask:0xf
v_fmac_f32_dpp v82, v79, v90 row_newbcast:5 row_mask:0xf bank_mask:0xf
v_fmac_f32_dpp v83, v79, v91 row_newbcast:5 row_mask:0xf bank_mask:0xf
v_fmac_f32_dpp v84, v79, v92 row_newbcast:5 row_mask:0xf bank_mask:0xf
v_fmac_f32_dpp v85, v79, v93 row_newbcast:5 row_mask:0xf bank_mask:0xf
v_fmac_f32_dpp v86, v79, v94 row_newbcast:5 row_mask:0xf bank_mask:0xf
v_fmac_f32_dpp v87, v79, v95 row_newbcast:5 row_mask:0xf bank_mask:0xf
s_waitcnt vmcnt(5)
buffer_load_dwordx4 v[32:35], v140, s[28:31], s42 offen offset:0 nt
v_lshlrev_b32 v88, 16, v40
v_and_b32 v89, s40, v40
v_lshlrev_b32 v90, 16, v41
v_and_b32 v91, s40, v41
v_lshlrev_b32 v92, 16, v42
v_and_b32 v93, s40, v42
v_lshlrev_b32 v94, 16, v43
v_and_b32 v95, s40, v43
v_fmac_f32_dpp v80, v79, v88 row_newbcast:6 row_mask:0xf bank_mask:0xf
v_fmac_f32_dpp v81, v79, v89 row_newbcast:6 row_mask:0xf bank_mask:0xf
v_fmac_f32_dpp v82, v79, v90 row_newbcast:6 row_mask:0xf bank_mask:0xf
v_fmac_f32_dpp v83, v79, v91 row_newbcast:6 row_mask:0xf bank_mask:0xf
v_fmac_f32_dpp v84, v79, v92 row_newbcast:6 row_mask:0xf bank_mask:0xf
v_fmac_f32_dpp v85, v79, v93 row_newbcast:6 row_mask:0xf bank_mask:0xf
v_fmac_f32_dpp v86, v79, v94 row_newbcast:6 row_mask:0xf bank_mask:0xf
v_fmac_f32_dpp v87, v79, v95 row_newbcast:6 row_mask:0xf bank_mask:0xf
s_waitcnt vmcnt(5)
buffer_load_dwordx4 v[36:39], v142, s[28:31], s42 offen offset:0 nt
v_lshlrev_b32 v88, 16, v44
v_and_b32 v89, s40, v44
v_lshlrev_b32 v90, 16, v45
v_and_b32 v91, s40, v45
v_lshlrev_b32 v92, 16, v46
v_and_b32 v93, s40, v46
v_lshlrev_b32 v94, 16, v47
v_and_b32 v95, s40, v47
v_fmac_f32_dpp v80, v79, v88 row_newbcast:7 row_mask:0xf bank_mask:0xf
v_fmac_f32_dpp v81, v79, v89 row_newbcast:7 row_mask:0xf bank_mask:0xf
v_fmac_f32_dpp v82, v79, v90 row_newbcast:7 row_mask:0xf bank_mask:0xf
v_fmac_f32_dpp v83, v79, v91 row_newbcast:7 row_mask:0xf bank_mask:0xf
v_fmac_f32_dpp v84, v79, v92 row_newbcast:7 row_mask:0xf bank_mask:0xf
v_fmac_f32_dpp v85, v79, v93 row_newbcast:7 row_mask:0xf bank_mask:0xf
v_fmac_f32_dpp v86, v79, v94 row_newbcast:7 row_mask:0xf bank_mask:0xf
v_fmac_f32_dpp v87, v79, v95 row_newbcast:7 row_mask:0xf bank_mask:0xf
v_add_u32 v78, 512, v78
s_cmp_eq_u32 s48, 0
s_cbranch_scc1 L_nt5
s_mov_b64 exec, 1
ds_add_u32 v6, v7 offset:80
s_mov_b64 exec, -1
L_nt5:
s_mov_b32 s41, s42
s_add_u32 s38, s38, 1
s_cmp_eq_u32 s38, 26
s_cbranch_scc1 L_dyn
s_and_b32 s43, s38, 7
s_cbranch_scc1 L_vloop
s_nop 1
v_permlane32_swap_b32 v80, v84
v_permlane32_swap_b32 v81, v85
v_permlane32_swap_b32 v82, v86
v_permlane32_swap_b32 v83, v87
v_add_f32 v80, v80, v84
v_add_f32 v81, v81, v85
v_add_f32 v82, v82, v86
v_add_f32 v83, v83, v87
s_nop 0
v_permlane16_swap_b32 v80, v82
v_permlane16_swap_b32 v81, v83
v_add_f32 v88, v80, v82
v_add_f32 v89, v81, v83
ds_write_b64 v96, v[88:89]
s_mov_b64 exec, 1
ds_add_u32 v97, v7 offset:0
s_mov_b64 exec, -1
v_add_u32 v97, 4, v97
v_mov_b32 v80, 0
v_mov_b32 v81, 0
v_mov_b32 v82, 0
v_mov_b32 v83, 0
v_mov_b32 v84, 0
v_mov_b32 v85, 0
v_mov_b32 v86, 0
v_mov_b32 v87, 0
v_add_u32 v78, 128, v78
v_add_u32 v96, 2048, v96
s_branch L_vhead
L_dyn:
ds_read_b32 v100, v6 offset:88
s_mov_b32 s64, s18
s_mov_b32 s65, s19
s_mov_b32 s66, 0x40000000
s_mov_b32 s67, 0x20000
s_mov_b32 s57, 0xffffff00
s_mov_b32 s58, 0x0c0c0400
s_mov_b32 s59, 0x04000c0c
s_mov_b32 s60, 0xffff0000
s_mov_b32 s61, 0xffff0000
s_mov_b32 s62, 0
s_mov_b32 s63, -1
v_and_b32 v108, 7, v0
v_lshlrev_b32 v108, 4, v108
s_waitcnt lgkmcnt(0)
v_readfirstlane_b32 s56, v100
L_dyn_own:
ds_read_b32 v79, v78
s_waitcnt vmcnt(5)
buffer_load_dwordx4 v[40:43], v141, s[28:31], s41 offen offset:0 nt
s_waitcnt lgkmcnt(0)
v_lshlrev_b32 v88, 16, v16
v_and_b32 v89, s40, v16
v_lshlrev_b32 v90, 16, v17
v_and_b32 v91, s40, v17
v_lshlrev_b32 v92, 16, v18
v_and_b32 v93, s40, v18
v_lshlrev_b32 v94, 16, v19
v_and_b32 v95, s40, v19
v_fmac_f32_dpp v80, v79, v88 row_newbcast:0 row_mask:0xf bank_mask:0xf
v_fmac_f32_dpp v81, v79, v89 row_newbcast:0 row_mask:0xf bank_mask:0xf
v_fmac_f32_dpp v82, v79, v90 row_newbcast:0 row_mask:0xf bank_mask:0xf
v_fmac_f32_dpp v83, v79, v91 row_newbcast:0 row_mask:0xf bank_mask:0xf
v_fmac_f32_dpp v84, v79, v92 row_newbcast:0 row_mask:0xf bank_mask:0xf
v_fmac_f32_dpp v85, v79, v93 row_newbcast:0 row_mask:0xf bank_mask:0xf
v_fmac_f32_dpp v86, v79, v94 row_newbcast:0 row_mask:0xf bank_mask:0xf
v_fmac_f32_dpp v87, v79, v95 row_newbcast:0 row_mask:0xf bank_mask:0xf
s_waitcnt vmcnt(5)
buffer_load_dwordx4 v[44:47], v143, s[28:31], s41 offen offset:0 nt
s_mov_b64 exec, 1
ds_add_rtn_u32 v100, v6, v7 offset:84
s_mov_b64 exec, -1
v_lshlrev_b32 v88, 16, v20
v_and_b32 v89, s40, v20
v_lshlrev_b32 v90, 16, v21
v_and_b32 v91, s40, v21
v_lshlrev_b32 v92, 16, v22
v_and_b32 v93, s40, v22
v_lshlrev_b32 v94, 16, v23
v_and_b32 v95, s40, v23
v_fmac_f32_dpp v80, v79, v88 row_newbcast:1 row_mask:0xf bank_mask:0xf
v_fmac_f32_dpp v81, v79, v89 row_newbcast:1 row_mask:0xf bank_mask:0xf
v_fmac_f32_dpp v82, v79, v90 row_newbcast:1 row_mask:0xf bank_mask:0xf
v_fmac_f32_dpp v83, v79, v91 row_newbcast:1 row_mask:0xf bank_mask:0xf
v_fmac_f32_dpp v84, v79, v92 row_newbcast:1 row_mask:0xf bank_mask:0xf
v_fmac_f32_dpp v85, v79, v93 row_newbcast:1 row_mask:0xf bank_mask:0xf
v_fmac_f32_dpp v86, v79, v94 row_newbcast:1 row_mask:0xf bank_mask:0xf
v_fmac_f32_dpp v87, v79, v95 row_newbcast:1 row_mask:0xf bank_mask:0xf
L_dyn_next:
s_waitcnt lgkmcnt(0)
v_readfirstlane_b32 s43, v100
s_mov_b32 s46, 0x40000
s_and_b32 s45, s43, 3
s_lshr_b32 s43, s43, 2
s_lshl_b32 s43, s43, 3
s_add_u32 s43, s43, 160384
v_mov_b32 v99, s43
L_dq:
ds_read_b64 v[100:101], v99
s_waitcnt lgkmcnt(0)
v_readfirstlane_b32 s43, v100
v_readfirstlane_b32 s51, v101
s_cmp_lg_u32 s43, 0
s_cbranch_scc1 L_dq_ok
s_sub_u32 s46, s46, 1
s_cbranch_scc1 L_drain
s_sleep 1
s_branch L_dq
L_dq_ok:
s_cmp_eq_u32 s43, -1
s_cbranch_scc1 L_drain
s_bfe_u32 s44, s45, 65536
s_lshl_b32 s44, s44, 11
s_add_u32 s42, s43, s44
s_bfe_u32 s44, s45, 65537
s_lshl_b32 s44, s44, 10
s_add_u32 s42, s42, s44
s_sub_u32 s42, s42, 1
s_bitcmp1_b32 s51, 31
s_cbranch_scc1 L_dyn_pool
s_waitcnt vmcnt(5)
buffer_load_dwordx4 v[16:19], v2, s[28:31], s42 offen offset:0 nt
v_lshlrev_b32 v88, 16, v24
v_and_b32 v89, s40, v24
v_lshlrev_b32 v90, 16, v25
v_and_b32 v91, s40, v25
v_lshlrev_b32 v92, 16, v26
v_and_b32 v93, s40, v26
v_lshlrev_b32 v94, 16, v27
v_and_b32 v95, s40, v27
v_fmac_f32_dpp v80, v79, v88 row_newbcast:2 row_mask:0xf bank_mask:0xf
v_fmac_f32_dpp v81, v79, v89 row_newbcast:2 row_mask:0xf bank_mask:0xf
v_fmac_f32_dpp v82, v79, v90 row_newbcast:2 row_mask:0xf bank_mask:0xf
v_fmac_f32_dpp v83, v79, v91 row_newbcast:2 row_mask:0xf bank_mask:0xf
v_fmac_f32_dpp v84, v79, v92 row_newbcast:2 row_mask:0xf bank_mask:0xf
v_fmac_f32_dpp v85, v79, v93 row_newbcast:2 row_mask:0xf bank_mask:0xf
v_fmac_f32_dpp v86, v79, v94 row_newbcast:2 row_mask:0xf bank_mask:0xf
v_fmac_f32_dpp v87, v79, v95 row_newbcast:2 row_mask:0xf bank_mask:0xf
s_waitcnt vmcnt(5)
buffer_load_dwordx4 v[20:23], v138, s[28:31], s42 offen offset:0 nt
v_lshlrev_b32 v88, 16, v28
v_and_b32 v89, s40, v28
v_lshlrev_b32 v90, 16, v29
v_and_b32 v91, s40, v29
v_lshlrev_b32 v92, 16, v30
v_and_b32 v93, s40, v30
v_lshlrev_b32 v94, 16, v31
v_and_b32 v95, s40, v31
v_fmac_f32_dpp v80, v79, v88 row_newbcast:3 row_mask:0xf bank_mask:0xf
v_fmac_f32_dpp v81, v79, v89 row_newbcast:3 row_mask:0xf bank_mask:0xf
v_fmac_f32_dpp v82, v79, v90 row_newbcast:3 row_mask:0xf bank_mask:0xf
v_fmac_f32_dpp v83, v79, v91 row_newbcast:3 row_mask:0xf bank_mask:0xf
v_fmac_f32_dpp v84, v79, v92 row_newbcast:3 row_mask:0xf bank_mask:0xf
v_fmac_f32_dpp v85, v79, v93 row_newbcast:3 row_mask:0xf bank_mask:0xf
v_fmac_f32_dpp v86, v79, v94 row_newbcast:3 row_mask:0xf bank_mask:0xf
v_fmac_f32_dpp v87, v79, v95 row_newbcast:3 row_mask:0xf bank_mask:0xf
s_waitcnt vmcnt(5)
buffer_load_dwordx4 v[24:27], v137, s[28:31], s42 offen offset:0 nt
v_lshlrev_b32 v88, 16, v32
v_and_b32 v89, s40, v32
v_lshlrev_b32 v90, 16, v33
v_and_b32 v91, s40, v33
v_lshlrev_b32 v92, 16, v34
v_and_b32 v93, s40, v34
v_lshlrev_b32 v94, 16, v35
v_and_b32 v95, s40, v35
v_fmac_f32_dpp v80, v79, v88 row_newbcast:4 row_mask:0xf bank_mask:0xf
v_fmac_f32_dpp v81, v79, v89 row_newbcast:4 row_mask:0xf bank_mask:0xf
v_fmac_f32_dpp v82, v79, v90 row_newbcast:4 row_mask:0xf bank_mask:0xf
v_fmac_f32_dpp v83, v79, v91 row_newbcast:4 row_mask:0xf bank_mask:0xf
v_fmac_f32_dpp v84, v79, v92 row_newbcast:4 row_mask:0xf bank_mask:0xf
v_fmac_f32_dpp v85, v79, v93 row_newbcast:4 row_mask:0xf bank_mask:0xf
v_fmac_f32_dpp v86, v79, v94 row_newbcast:4 row_mask:0xf bank_mask:0xf
v_fmac_f32_dpp v87, v79, v95 row_newbcast:4 row_mask:0xf bank_mask:0xf
s_waitcnt vmcnt(5)
buffer_load_dwordx4 v[28:31], v139, s[28:31], s42 offen offset:0 nt
v_lshlrev_b32 v88, 16, v36
v_and_b32 v89, s40, v36
v_lshlrev_b32 v90, 16, v37
v_and_b32 v91, s40, v37
v_lshlrev_b32 v92, 16, v38
v_and_b32 v93, s40, v38
v_lshlrev_b32 v94, 16, v39
v_and_b32 v95, s40, v39
v_fmac_f32_dpp v80, v79, v88 row_newbcast:5 row_mask:0xf bank_mask:0xf
v_fmac_f32_dpp v81, v79, v89 row_newbcast:5 row_mask:0xf bank_mask:0xf
v_fmac_f32_dpp v82, v79, v90 row_newbcast:5 row_mask:0xf bank_mask:0xf
v_fmac_f32_dpp v83, v79, v91 row_newbcast:5 row_mask:0xf bank_mask:0xf
v_fmac_f32_dpp v84, v79, v92 row_newbcast:5 row_mask:0xf bank_mask:0xf
v_fmac_f32_dpp v85, v79, v93 row_newbcast:5 row_mask:0xf bank_mask:0xf
v_fmac_f32_dpp v86, v79, v94 row_newbcast:5 row_mask:0xf bank_mask:0xf
v_fmac_f32_dpp v87, v79, v95 row_newbcast:5 row_mask:0xf bank_mask:0xf
s_waitcnt vmcnt(5)
buffer_load_dwordx4 v[32:35], v140, s[28:31], s42 offen offset:0 nt
v_lshlrev_b32 v88, 16, v40
v_and_b32 v89, s40, v40
v_lshlrev_b32 v90, 16, v41
v_and_b32 v91, s40, v41
v_lshlrev_b32 v92, 16, v42
v_and_b32 v93, s40, v42
v_lshlrev_b32 v94, 16, v43
v_and_b32 v95, s40, v43
v_fmac_f32_dpp v80, v79, v88 row_newbcast:6 row_mask:0xf bank_mask:0xf
v_fmac_f32_dpp v81, v79, v89 row_newbcast:6 row_mask:0xf bank_mask:0xf
v_fmac_f32_dpp v82, v79, v90 row_newbcast:6 row_mask:0xf bank_mask:0xf
v_fmac_f32_dpp v83, v79, v91 row_newbcast:6 row_mask:0xf bank_mask:0xf
v_fmac_f32_dpp v84, v79, v92 row_newbcast:6 row_mask:0xf bank_mask:0xf
v_fmac_f32_dpp v85, v79, v93 row_newbcast:6 row_mask:0xf bank_mask:0xf
v_fmac_f32_dpp v86, v79, v94 row_newbcast:6 row_mask:0xf bank_mask:0xf
v_fmac_f32_dpp v87, v79, v95 row_newbcast:6 row_mask:0xf bank_mask:0xf
s_waitcnt vmcnt(5)
buffer_load_dwordx4 v[36:39], v142, s[28:31], s42 offen offset:0 nt
v_lshlrev_b32 v88, 16, v44
v_and_b32 v89, s40, v44
v_lshlrev_b32 v90, 16, v45
v_and_b32 v91, s40, v45
v_lshlrev_b32 v92, 16, v46
v_and_b32 v93, s40, v46
v_lshlrev_b32 v94, 16, v47
v_and_b32 v95, s40, v47
v_fmac_f32_dpp v80, v79, v88 row_newbcast:7 row_mask:0xf bank_mask:0xf
v_fmac_f32_dpp v81, v79, v89 row_newbcast:7 row_mask:0xf bank_mask:0xf
v_fmac_f32_dpp v82, v79, v90 row_newbcast:7 row_mask:0xf bank_mask:0xf
v_fmac_f32_dpp v83, v79, v91 row_newbcast:7 row_mask:0xf bank_mask:0xf
v_fmac_f32_dpp v84, v79, v92 row_newbcast:7 row_mask:0xf bank_mask:0xf
v_fmac_f32_dpp v85, v79, v93 row_newbcast:7 row_mask:0xf bank_mask:0xf
v_fmac_f32_dpp v86, v79, v94 row_newbcast:7 row_mask:0xf bank_mask:0xf
v_fmac_f32_dpp v87, v79, v95 row_newbcast:7 row_mask:0xf bank_mask:0xf
s_bfe_u32 s44, s45, 65536
s_lshl_b32 s44, s44, 5
s_add_u32 s43, s51, s44
s_bfe_u32 s44, s45, 65537
s_lshl_b32 s44, s44, 4
s_add_u32 s43, s43, s44
v_add_u32 v78, s43, v98
s_mov_b32 s41, s42
s_branch L_dyn_own
L_dyn_pool:
s_bitset0_b32 s51, 31
s_bfe_u32 s44, s45, 65536
s_lshl_b32 s44, s44, 7
s_add_u32 s51, s51, s44
s_bfe_u32 s44, s45, 65537
s_lshl_b32 s44, s44, 15
s_add_u32 s51, s51, s44
s_waitcnt vmcnt(5)
buffer_load_dwordx4 v[104:107], v108, s[64:67], s51 offen sc1
buffer_load_dwordx4 v[16:19], v2, s[28:31], s42 offen offset:0 nt
v_lshlrev_b32 v88, 16, v24
v_and_b32 v89, s40, v24
v_lshlrev_b32 v90, 16, v25
v_and_b32 v91, s40, v25
v_lshlrev_b32 v92, 16, v26
v_and_b32 v93, s40, v26
v_lshlrev_b32 v94, 16, v27
v_and_b32 v95, s40, v27
v_fmac_f32_dpp v80, v79, v88 row_newbcast:2 row_mask:0xf bank_mask:0xf
v_fmac_f32_dpp v81, v79, v89 row_newbcast:2 row_mask:0xf bank_mask:0xf
v_fmac_f32_dpp v82, v79, v90 row_newbcast:2 row_mask:0xf bank_mask:0xf
v_fmac_f32_dpp v83, v79, v91 row_newbcast:2 row_mask:0xf bank_mask:0xf
v_fmac_f32_dpp v84, v79, v92 row_newbcast:2 row_mask:0xf bank_mask:0xf
v_fmac_f32_dpp v85, v79, v93 row_newbcast:2 row_mask:0xf bank_mask:0xf
v_fmac_f32_dpp v86, v79, v94 row_newbcast:2 row_mask:0xf bank_mask:0xf
v_fmac_f32_dpp v87, v79, v95 row_newbcast:2 row_mask:0xf bank_mask:0xf
s_waitcnt vmcnt(6)
buffer_load_dwordx4 v[20:23], v138, s[28:31], s42 offen offset:0 nt
v_lshlrev_b32 v88, 16, v28
v_and_b32 v89, s40, v28
v_lshlrev_b32 v90, 16, v29
v_and_b32 v91, s40, v29
v_lshlrev_b32 v92, 16, v30
v_and_b32 v93, s40, v30
v_lshlrev_b32 v94, 16, v31
v_and_b32 v95, s40, v31
v_fmac_f32_dpp v80, v79, v88 row_newbcast:3 row_mask:0xf bank_mask:0xf
v_fmac_f32_dpp v81, v79, v89 row_newbcast:3 row_mask:0xf bank_mask:0xf
v_fmac_f32_dpp v82, v79, v90 row_newbcast:3 row_mask:0xf bank_mask:0xf
v_fmac_f32_dpp v83, v79, v91 row_newbcast:3 row_mask:0xf bank_mask:0xf
v_fmac_f32_dpp v84, v79, v92 row_newbcast:3 row_mask:0xf bank_mask:0xf
v_fmac_f32_dpp v85, v79, v93 row_newbcast:3 row_mask:0xf bank_mask:0xf
v_fmac_f32_dpp v86, v79, v94 row_newbcast:3 row_mask:0xf bank_mask:0xf
v_fmac_f32_dpp v87, v79, v95 row_newbcast:3 row_mask:0xf bank_mask:0xf
s_waitcnt vmcnt(6)
buffer_load_dwordx4 v[24:27], v137, s[28:31], s42 offen offset:0 nt
v_lshlrev_b32 v88, 16, v32
v_and_b32 v89, s40, v32
v_lshlrev_b32 v90, 16, v33
v_and_b32 v91, s40, v33
v_lshlrev_b32 v92, 16, v34
v_and_b32 v93, s40, v34
v_lshlrev_b32 v94, 16, v35
v_and_b32 v95, s40, v35
v_fmac_f32_dpp v80, v79, v88 row_newbcast:4 row_mask:0xf bank_mask:0xf
v_fmac_f32_dpp v81, v79, v89 row_newbcast:4 row_mask:0xf bank_mask:0xf
v_fmac_f32_dpp v82, v79, v90 row_newbcast:4 row_mask:0xf bank_mask:0xf
v_fmac_f32_dpp v83, v79, v91 row_newbcast:4 row_mask:0xf bank_mask:0xf
v_fmac_f32_dpp v84, v79, v92 row_newbcast:4 row_mask:0xf bank_mask:0xf
v_fmac_f32_dpp v85, v79, v93 row_newbcast:4 row_mask:0xf bank_mask:0xf
v_fmac_f32_dpp v86, v79, v94 row_newbcast:4 row_mask:0xf bank_mask:0xf
v_fmac_f32_dpp v87, v79, v95 row_newbcast:4 row_mask:0xf bank_mask:0xf
s_waitcnt vmcnt(6)
buffer_load_dwordx4 v[28:31], v139, s[28:31], s42 offen offset:0 nt
v_lshlrev_b32 v88, 16, v36
v_and_b32 v89, s40, v36
v_lshlrev_b32 v90, 16, v37
v_and_b32 v91, s40, v37
v_lshlrev_b32 v92, 16, v38
v_and_b32 v93, s40, v38
v_lshlrev_b32 v94, 16, v39
v_and_b32 v95, s40, v39
v_fmac_f32_dpp v80, v79, v88 row_newbcast:5 row_mask:0xf bank_mask:0xf
v_fmac_f32_dpp v81, v79, v89 row_newbcast:5 row_mask:0xf bank_mask:0xf
v_fmac_f32_dpp v82, v79, v90 row_newbcast:5 row_mask:0xf bank_mask:0xf
v_fmac_f32_dpp v83, v79, v91 row_newbcast:5 row_mask:0xf bank_mask:0xf
v_fmac_f32_dpp v84, v79, v92 row_newbcast:5 row_mask:0xf bank_mask:0xf
v_fmac_f32_dpp v85, v79, v93 row_newbcast:5 row_mask:0xf bank_mask:0xf
v_fmac_f32_dpp v86, v79, v94 row_newbcast:5 row_mask:0xf bank_mask:0xf
v_fmac_f32_dpp v87, v79, v95 row_newbcast:5 row_mask:0xf bank_mask:0xf
s_waitcnt vmcnt(6)
buffer_load_dwordx4 v[32:35], v140, s[28:31], s42 offen offset:0 nt
v_lshlrev_b32 v88, 16, v40
v_and_b32 v89, s40, v40
v_lshlrev_b32 v90, 16, v41
v_and_b32 v91, s40, v41
v_lshlrev_b32 v92, 16, v42
v_and_b32 v93, s40, v42
v_lshlrev_b32 v94, 16, v43
v_and_b32 v95, s40, v43
v_fmac_f32_dpp v80, v79, v88 row_newbcast:6 row_mask:0xf bank_mask:0xf
v_fmac_f32_dpp v81, v79, v89 row_newbcast:6 row_mask:0xf bank_mask:0xf
v_fmac_f32_dpp v82, v79, v90 row_newbcast:6 row_mask:0xf bank_mask:0xf
v_fmac_f32_dpp v83, v79, v91 row_newbcast:6 row_mask:0xf bank_mask:0xf
v_fmac_f32_dpp v84, v79, v92 row_newbcast:6 row_mask:0xf bank_mask:0xf
v_fmac_f32_dpp v85, v79, v93 row_newbcast:6 row_mask:0xf bank_mask:0xf
v_fmac_f32_dpp v86, v79, v94 row_newbcast:6 row_mask:0xf bank_mask:0xf
v_fmac_f32_dpp v87, v79, v95 row_newbcast:6 row_mask:0xf bank_mask:0xf
s_waitcnt vmcnt(6)
buffer_load_dwordx4 v[36:39], v142, s[28:31], s42 offen offset:0 nt
v_lshlrev_b32 v88, 16, v44
v_and_b32 v89, s40, v44
v_lshlrev_b32 v90, 16, v45
v_and_b32 v91, s40, v45
v_lshlrev_b32 v92, 16, v46
v_and_b32 v93, s40, v46
v_lshlrev_b32 v94, 16, v47
v_and_b32 v95, s40, v47
v_fmac_f32_dpp v80, v79, v88 row_newbcast:7 row_mask:0xf bank_mask:0xf
v_fmac_f32_dpp v81, v79, v89 row_newbcast:7 row_mask:0xf bank_mask:0xf
v_fmac_f32_dpp v82, v79, v90 row_newbcast:7 row_mask:0xf bank_mask:0xf
v_fmac_f32_dpp v83, v79, v91 row_newbcast:7 row_mask:0xf bank_mask:0xf
v_fmac_f32_dpp v84, v79, v92 row_newbcast:7 row_mask:0xf bank_mask:0xf
v_fmac_f32_dpp v85, v79, v93 row_newbcast:7 row_mask:0xf bank_mask:0xf
v_fmac_f32_dpp v86, v79, v94 row_newbcast:7 row_mask:0xf bank_mask:0xf
v_fmac_f32_dpp v87, v79, v95 row_newbcast:7 row_mask:0xf bank_mask:0xf
s_mov_b32 s41, s42
s_waitcnt vmcnt(5)
buffer_load_dwordx4 v[40:43], v141, s[28:31], s41 offen offset:0 nt
s_mov_b32 s46, 0x8000
L_wchk:
v_perm_b32 v109, v105, v104, s58
v_perm_b32 v110, v107, v106, s59
v_or_b32 v109, v109, v110
v_cmp_ne_u32 vcc, s56, v109
v_cndmask_b32 v109, v104, v105, s[60:61]
v_cndmask_b32 v110, v106, v107, s[60:61]
s_cmp_lg_u64 vcc, 0
s_cbranch_scc1 L_wretry
L_wok:
v_cndmask_b32 v79, v109, v110, s[62:63]
v_and_b32 v79, s57, v79
v_lshlrev_b32 v88, 16, v16
v_and_b32 v89, s40, v16
v_lshlrev_b32 v90, 16, v17
v_and_b32 v91, s40, v17
v_lshlrev_b32 v92, 16, v18
v_and_b32 v93, s40, v18
v_lshlrev_b32 v94, 16, v19
v_and_b32 v95, s40, v19
v_fmac_f32_dpp v80, v79, v88 row_newbcast:0 row_mask:0xf bank_mask:0xf
v_fmac_f32_dpp v81, v79, v89 row_newbcast:0 row_mask:0xf bank_mask:0xf
v_fmac_f32_dpp v82, v79, v90 row_newbcast:0 row_mask:0xf bank_mask:0xf
v_fmac_f32_dpp v83, v79, v91 row_newbcast:0 row_mask:0xf bank_mask:0xf
v_fmac_f32_dpp v84, v79, v92 row_newbcast:0 row_mask:0xf bank_mask:0xf
v_fmac_f32_dpp v85, v79, v93 row_newbcast:0 row_mask:0xf bank_mask:0xf
v_fmac_f32_dpp v86, v79, v94 row_newbcast:0 row_mask:0xf bank_mask:0xf
v_fmac_f32_dpp v87, v79, v95 row_newbcast:0 row_mask:0xf bank_mask:0xf
s_waitcnt vmcnt(5)
buffer_load_dwordx4 v[44:47], v143, s[28:31], s41 offen offset:0 nt
s_mov_b64 exec, 1
ds_add_rtn_u32 v100, v6, v7 offset:84
s_mov_b64 exec, -1
v_lshlrev_b32 v88, 16, v20
v_and_b32 v89, s40, v20
v_lshlrev_b32 v90, 16, v21
v_and_b32 v91, s40, v21
v_lshlrev_b32 v92, 16, v22
v_and_b32 v93, s40, v22
v_lshlrev_b32 v94, 16, v23
v_and_b32 v95, s40, v23
v_fmac_f32_dpp v80, v79, v88 row_newbcast:1 row_mask:0xf bank_mask:0xf
v_fmac_f32_dpp v81, v79, v89 row_newbcast:1 row_mask:0xf bank_mask:0xf
v_fmac_f32_dpp v82, v79, v90 row_newbcast:1 row_mask:0xf bank_mask:0xf
v_fmac_f32_dpp v83, v79, v91 row_newbcast:1 row_mask:0xf bank_mask:0xf
v_fmac_f32_dpp v84, v79, v92 row_newbcast:1 row_mask:0xf bank_mask:0xf
v_fmac_f32_dpp v85, v79, v93 row_newbcast:1 row_mask:0xf bank_mask:0xf
v_fmac_f32_dpp v86, v79, v94 row_newbcast:1 row_mask:0xf bank_mask:0xf
v_fmac_f32_dpp v87, v79, v95 row_newbcast:1 row_mask:0xf bank_mask:0xf
s_branch L_dyn_next
L_wretry:
s_sub_u32 s46, s46, 1
s_cbranch_scc1 L_wok
s_sleep 8
buffer_load_dwordx4 v[104:107], v108, s[64:67], s51 offen sc1
s_waitcnt vmcnt(0)
s_branch L_wchk
L_drain:
s_waitcnt vmcnt(5)
v_lshlrev_b32 v88, 16, v24
v_and_b32 v89, s40, v24
v_lshlrev_b32 v90, 16, v25
v_and_b32 v91, s40, v25
v_lshlrev_b32 v92, 16, v26
v_and_b32 v93, s40, v26
v_lshlrev_b32 v94, 16, v27
v_and_b32 v95, s40, v27
v_fmac_f32_dpp v80, v79, v88 row_newbcast:2 row_mask:0xf bank_mask:0xf
v_fmac_f32_dpp v81, v79, v89 row_newbcast:2 row_mask:0xf bank_mask:0xf
v_fmac_f32_dpp v82, v79, v90 row_newbcast:2 row_mask:0xf bank_mask:0xf
v_fmac_f32_dpp v83, v79, v91 row_newbcast:2 row_mask:0xf bank_mask:0xf
v_fmac_f32_dpp v84, v79, v92 row_newbcast:2 row_mask:0xf bank_mask:0xf
v_fmac_f32_dpp v85, v79, v93 row_newbcast:2 row_mask:0xf bank_mask:0xf
v_fmac_f32_dpp v86, v79, v94 row_newbcast:2 row_mask:0xf bank_mask:0xf
v_fmac_f32_dpp v87, v79, v95 row_newbcast:2 row_mask:0xf bank_mask:0xf
s_waitcnt vmcnt(4)
v_lshlrev_b32 v88, 16, v28
v_and_b32 v89, s40, v28
v_lshlrev_b32 v90, 16, v29
v_and_b32 v91, s40, v29
v_lshlrev_b32 v92, 16, v30
v_and_b32 v93, s40, v30
v_lshlrev_b32 v94, 16, v31
v_and_b32 v95, s40, v31
v_fmac_f32_dpp v80, v79, v88 row_newbcast:3 row_mask:0xf bank_mask:0xf
v_fmac_f32_dpp v81, v79, v89 row_newbcast:3 row_mask:0xf bank_mask:0xf
v_fmac_f32_dpp v82, v79, v90 row_newbcast:3 row_mask:0xf bank_mask:0xf
v_fmac_f32_dpp v83, v79, v91 row_newbcast:3 row_mask:0xf bank_mask:0xf
v_fmac_f32_dpp v84, v79, v92 row_newbcast:3 row_mask:0xf bank_mask:0xf
v_fmac_f32_dpp v85, v79, v93 row_newbcast:3 row_mask:0xf bank_mask:0xf
v_fmac_f32_dpp v86, v79, v94 row_newbcast:3 row_mask:0xf bank_mask:0xf
v_fmac_f32_dpp v87, v79, v95 row_newbcast:3 row_mask:0xf bank_mask:0xf
s_waitcnt vmcnt(3)
v_lshlrev_b32 v88, 16, v32
v_and_b32 v89, s40, v32
v_lshlrev_b32 v90, 16, v33
v_and_b32 v91, s40, v33
v_lshlrev_b32 v92, 16, v34
v_and_b32 v93, s40, v34
v_lshlrev_b32 v94, 16, v35
v_and_b32 v95, s40, v35
v_fmac_f32_dpp v80, v79, v88 row_newbcast:4 row_mask:0xf bank_mask:0xf
v_fmac_f32_dpp v81, v79, v89 row_newbcast:4 row_mask:0xf bank_mask:0xf
v_fmac_f32_dpp v82, v79, v90 row_newbcast:4 row_mask:0xf bank_mask:0xf
v_fmac_f32_dpp v83, v79, v91 row_newbcast:4 row_mask:0xf bank_mask:0xf
v_fmac_f32_dpp v84, v79, v92 row_newbcast:4 row_mask:0xf bank_mask:0xf
v_fmac_f32_dpp v85, v79, v93 row_newbcast:4 row_mask:0xf bank_mask:0xf
v_fmac_f32_dpp v86, v79, v94 row_newbcast:4 row_mask:0xf bank_mask:0xf
v_fmac_f32_dpp v87, v79, v95 row_newbcast:4 row_mask:0xf bank_mask:0xf
s_waitcnt vmcnt(2)
v_lshlrev_b32 v88, 16, v36
v_and_b32 v89, s40, v36
v_lshlrev_b32 v90, 16, v37
v_and_b32 v91, s40, v37
v_lshlrev_b32 v92, 16, v38
v_and_b32 v93, s40, v38
v_lshlrev_b32 v94, 16, v39
v_and_b32 v95, s40, v39
v_fmac_f32_dpp v80, v79, v88 row_newbcast:5 row_mask:0xf bank_mask:0xf
v_fmac_f32_dpp v81, v79, v89 row_newbcast:5 row_mask:0xf bank_mask:0xf
v_fmac_f32_dpp v82, v79, v90 row_newbcast:5 row_mask:0xf bank_mask:0xf
v_fmac_f32_dpp v83, v79, v91 row_newbcast:5 row_mask:0xf bank_mask:0xf
v_fmac_f32_dpp v84, v79, v92 row_newbcast:5 row_mask:0xf bank_mask:0xf
v_fmac_f32_dpp v85, v79, v93 row_newbcast:5 row_mask:0xf bank_mask:0xf
v_fmac_f32_dpp v86, v79, v94 row_newbcast:5 row_mask:0xf bank_mask:0xf
v_fmac_f32_dpp v87, v79, v95 row_newbcast:5 row_mask:0xf bank_mask:0xf
s_waitcnt vmcnt(1)
v_lshlrev_b32 v88, 16, v40
v_and_b32 v89, s40, v40
v_lshlrev_b32 v90, 16, v41
v_and_b32 v91, s40, v41
v_lshlrev_b32 v92, 16, v42
v_and_b32 v93, s40, v42
v_lshlrev_b32 v94, 16, v43
v_and_b32 v95, s40, v43
v_fmac_f32_dpp v80, v79, v88 row_newbcast:6 row_mask:0xf bank_mask:0xf
v_fmac_f32_dpp v81, v79, v89 row_newbcast:6 row_mask:0xf bank_mask:0xf
v_fmac_f32_dpp v82, v79, v90 row_newbcast:6 row_mask:0xf bank_mask:0xf
v_fmac_f32_dpp v83, v79, v91 row_newbcast:6 row_mask:0xf bank_mask:0xf
v_fmac_f32_dpp v84, v79, v92 row_newbcast:6 row_mask:0xf bank_mask:0xf
v_fmac_f32_dpp v85, v79, v93 row_newbcast:6 row_mask:0xf bank_mask:0xf
v_fmac_f32_dpp v86, v79, v94 row_newbcast:6 row_mask:0xf bank_mask:0xf
v_fmac_f32_dpp v87, v79, v95 row_newbcast:6 row_mask:0xf bank_mask:0xf
s_waitcnt vmcnt(0)
v_lshlrev_b32 v88, 16, v44
v_and_b32 v89, s40, v44
v_lshlrev_b32 v90, 16, v45
v_and_b32 v91, s40, v45
v_lshlrev_b32 v92, 16, v46
v_and_b32 v93, s40, v46
v_lshlrev_b32 v94, 16, v47
v_and_b32 v95, s40, v47
v_fmac_f32_dpp v80, v79, v88 row_newbcast:7 row_mask:0xf bank_mask:0xf
v_fmac_f32_dpp v81, v79, v89 row_newbcast:7 row_mask:0xf bank_mask:0xf
v_fmac_f32_dpp v82, v79, v90 row_newbcast:7 row_mask:0xf bank_mask:0xf
v_fmac_f32_dpp v83, v79, v91 row_newbcast:7 row_mask:0xf bank_mask:0xf
v_fmac_f32_dpp v84, v79, v92 row_newbcast:7 row_mask:0xf bank_mask:0xf
v_fmac_f32_dpp v85, v79, v93 row_newbcast:7 row_mask:0xf bank_mask:0xf
v_fmac_f32_dpp v86, v79, v94 row_newbcast:7 row_mask:0xf bank_mask:0xf
v_fmac_f32_dpp v87, v79, v95 row_newbcast:7 row_mask:0xf bank_mask:0xf
s_nop 1
v_permlane32_swap_b32 v80, v84
v_permlane32_swap_b32 v81, v85
v_permlane32_swap_b32 v82, v86
v_permlane32_swap_b32 v83, v87
v_add_f32 v80, v80, v84
v_add_f32 v81, v81, v85
v_add_f32 v82, v82, v86
v_add_f32 v83, v83, v87
s_nop 0
v_permlane16_swap_b32 v80, v82
v_permlane16_swap_b32 v81, v83
v_add_f32 v88, v80, v82
v_add_f32 v89, v81, v83
ds_write_b64 v96, v[88:89]
s_mov_b64 exec, 1
ds_add_u32 v97, v7 offset:0
s_mov_b64 exec, -1
v_add_u32 v97, 4, v97
s_endpgm
L_helper:
s_sub_u32 s22, s3, 4
v_mov_b32 v8, 0
v_lshl_add_u32 v9, v0, 2, v6
ds_write_b32 v9, v8 offset:0
ds_write_b32 v9, v8 offset:256
ds_write_b32 v9, v8 offset:512
ds_write_b32 v9, v8 offset:768
s_waitcnt lgkmcnt(0)
s_barrier
s_mov_b32 s32, s18
s_mov_b32 s33, s19
s_mov_b32 s34, 0x40000000
s_mov_b32 s35, 0x20000
s_lshl_b32 s47, s21, 8
buffer_load_dword v20, off, s[32:35], s47 sc1
s_add_u32 s68, s47, 4096
s_or_b32 s43, s20, s22
s_cbranch_scc1 L_noinit
s_mov_b64 exec, 1
buffer_store_dword v8, off, s[32:35], s68 sc1
s_mov_b64 exec, -1
L_noinit:
s_mov_b32 s24, s10
s_mov_b32 s25, s11
s_mov_b32 s26, 0x200000
s_mov_b32 s27, 0x20000
s_mov_b32 s28, s12
s_mov_b32 s29, s13
s_mov_b32 s30, 0x200000
s_mov_b32 s31, 0x20000
s_mov_b32 s52, s14
s_mov_b32 s53, s15
s_mov_b32 s54, 16384
s_mov_b32 s55, 0x20000
s_lshl_b32 s36, s22, 19
s_bfe_u32 s37, s20, 196608
s_lshl_b32 s37, s37, 9
s_bfe_u32 s43, s20, 65539
s_lshl_b32 s43, s43, 14
s_add_u32 s37, s37, s43
s_add_u32 s36, s36, s37
v_and_b32 v8, 1, v4
v_lshlrev_b32 v8, 8, v8
v_lshrrev_b32 v9, 1, v4
v_lshlrev_b32 v9, 12, v9
v_add_u32 v8, v8, v9
v_lshl_add_u32 v124, v5, 4, v8
v_add_u32 v125, 8192, v124
s_mul_i32 s38, s22, 33024
s_lshl_b32 s43, s21, 2
s_add_u32 s43, s43, s22
s_lshl_b32 s43, s43, 15
s_add_u32 s43, s43, s37
buffer_load_dwordx4 v[128:131], v124, s[24:27], s43 offen
buffer_load_dwordx4 v[132:135], v125, s[24:27], s43 offen
buffer_load_dwordx4 v[136:139], v124, s[28:31], s43 offen
buffer_load_dwordx4 v[140:143], v125, s[28:31], s43 offen
s_waitcnt vmcnt(0)
s_mov_b32 s45, s43
s_add_u32 m0, s38, 0
s_waitcnt vmcnt(1)
buffer_load_dwordx4 v124, s[24:27], s36 offen nt lds
s_add_u32 m0, s38, 1024
s_waitcnt vmcnt(1)
buffer_load_dwordx4 v125, s[24:27], s36 offen nt lds
s_add_u32 s36, s36, 32768
s_add_u32 m0, s38, 2064
s_waitcnt vmcnt(1)
buffer_load_dwordx4 v124, s[24:27], s36 offen nt lds
s_add_u32 m0, s38, 3088
s_waitcnt vmcnt(1)
buffer_load_dwordx4 v125, s[24:27], s36 offen nt lds
s_add_u32 s36, s36, 32768
s_add_u32 m0, s38, 4128
s_waitcnt vmcnt(1)
buffer_load_dwordx4 v124, s[24:27], s36 offen nt lds
s_add_u32 m0, s38, 5152
s_waitcnt vmcnt(1)
buffer_load_dwordx4 v125, s[24:27], s36 offen nt lds
s_add_u32 s36, s36, 32768
s_add_u32 m0, s38, 6192
s_waitcnt vmcnt(1)
buffer_load_dwordx4 v124, s[24:27], s36 offen nt lds
s_add_u32 m0, s38, 7216
s_waitcnt vmcnt(1)
buffer_load_dwordx4 v125, s[24:27], s36 offen nt lds
s_add_u32 s36, s36, 32768
s_add_u32 m0, s38, 8256
s_waitcnt vmcnt(1)
buffer_load_dwordx4 v124, s[24:27], s36 offen nt lds
s_add_u32 m0, s38, 9280
s_waitcnt vmcnt(1)
buffer_load_dwordx4 v125, s[24:27], s36 offen nt lds
s_add_u32 s36, s36, 32768
s_add_u32 m0, s38, 10320
s_waitcnt vmcnt(1)
buffer_load_dwordx4 v124, s[24:27], s36 offen nt lds
s_add_u32 m0, s38, 11344
s_waitcnt vmcnt(1)
buffer_load_dwordx4 v125, s[24:27], s36 offen nt lds
s_add_u32 s36, s36, 32768
s_add_u32 m0, s38, 12384
s_waitcnt vmcnt(1)
buffer_load_dwordx4 v124, s[24:27], s36 offen nt lds
s_add_u32 m0, s38, 13408
s_waitcnt vmcnt(1)
buffer_load_dwordx4 v125, s[24:27], s36 offen nt lds
s_add_u32 s36, s36, 32768
s_add_u32 m0, s38, 14448
s_waitcnt vmcnt(1)
buffer_load_dwordx4 v124, s[24:27], s36 offen nt lds
s_add_u32 m0, s38, 15472
s_waitcnt vmcnt(1)
buffer_load_dwordx4 v125, s[24:27], s36 offen nt lds
s_add_u32 s36, s36, 32768
s_add_u32 m0, s38, 16512
s_waitcnt vmcnt(1)
buffer_load_dwordx4 v124, s[24:27], s36 offen nt lds
s_add_u32 m0, s38, 17536
s_waitcnt vmcnt(1)
buffer_load_dwordx4 v125, s[24:27], s36 offen nt lds
s_add_u32 s36, s36, 32768
s_add_u32 m0, s38, 18576
s_waitcnt vmcnt(1)
buffer_load_dwordx4 v124, s[24:27], s36 offen nt lds
s_add_u32 m0, s38, 19600
s_waitcnt vmcnt(1)
buffer_load_dwordx4 v125, s[24:27], s36 offen nt lds
s_add_u32 s36, s36, 32768
s_add_u32 m0, s38, 20640
s_waitcnt vmcnt(1)
buffer_load_dwordx4 v124, s[24:27], s36 offen nt lds
s_add_u32 m0, s38, 21664
s_waitcnt vmcnt(1)
buffer_load_dwordx4 v125, s[24:27], s36 offen nt lds
s_add_u32 s36, s36, 32768
s_add_u32 m0, s38, 22704
s_waitcnt vmcnt(1)
buffer_load_dwordx4 v124, s[24:27], s36 offen nt lds
s_add_u32 m0, s38, 23728
s_waitcnt vmcnt(1)
buffer_load_dwordx4 v125, s[24:27], s36 offen nt lds
s_add_u32 s36, s36, 32768
s_add_u32 m0, s38, 24768
s_waitcnt vmcnt(1)
buffer_load_dwordx4 v124, s[24:27], s36 offen nt lds
s_add_u32 m0, s38, 25792
s_waitcnt vmcnt(1)
buffer_load_dwordx4 v125, s[24:27], s36 offen nt lds
s_add_u32 s36, s36, 32768
s_add_u32 m0, s38, 26832
s_waitcnt vmcnt(1)
buffer_load_dwordx4 v124, s[24:27], s36 offen nt lds
s_add_u32 m0, s38, 27856
s_waitcnt vmcnt(1)
buffer_load_dwordx4 v125, s[24:27], s36 offen nt lds
s_add_u32 s36, s36, 32768
s_add_u32 m0, s38, 28896
s_waitcnt vmcnt(1)
buffer_load_dwordx4 v124, s[24:27], s36 offen nt lds
s_add_u32 m0, s38, 29920
s_waitcnt vmcnt(1)
buffer_load_dwordx4 v125, s[24:27], s36 offen nt lds
s_add_u32 s36, s36, 32768
s_add_u32 m0, s38, 30960
s_waitcnt vmcnt(1)
buffer_load_dwordx4 v124, s[24:27], s36 offen nt lds
s_add_u32 m0, s38, 31984
s_waitcnt vmcnt(1)
buffer_load_dwordx4 v125, s[24:27], s36 offen nt lds
s_add_u32 s36, s36, 32768
v_lshlrev_b32 v3, 15, v4
v_lshl_add_u32 v3, v5, 4, v3
v_add_u32 v126, 256, v3
s_lshl_b32 s43, s22, 12
s_add_u32 s36, s37, s43
s_waitcnt vmcnt(1)
buffer_load_dwordx4 v[128:131], v3, s[28:31], s36 offen nt
s_waitcnt vmcnt(1)
buffer_load_dwordx4 v[192:195], v126, s[28:31], s36 offen nt
s_add_u32 s36, s36, 131072
s_waitcnt vmcnt(1)
buffer_load_dwordx4 v[132:135], v3, s[28:31], s36 offen nt
s_waitcnt vmcnt(1)
buffer_load_dwordx4 v[196:199], v126, s[28:31], s36 offen nt
s_add_u32 s36, s36, 131072
s_waitcnt vmcnt(1)
buffer_load_dwordx4 v[136:139], v3, s[28:31], s36 offen nt
s_waitcnt vmcnt(1)
buffer_load_dwordx4 v[200:203], v126, s[28:31], s36 offen nt
s_add_u32 s36, s36, 131072
s_waitcnt vmcnt(1)
buffer_load_dwordx4 v[140:143], v3, s[28:31], s36 offen nt
s_waitcnt vmcnt(1)
buffer_load_dwordx4 v[204:207], v126, s[28:31], s36 offen nt
s_add_u32 s36, s36, 131072
s_waitcnt vmcnt(1)
buffer_load_dwordx4 v[144:147], v3, s[28:31], s36 offen nt
s_waitcnt vmcnt(1)
buffer_load_dwordx4 v[208:211], v126, s[28:31], s36 offen nt
s_add_u32 s36, s36, 131072
s_waitcnt vmcnt(1)
buffer_load_dwordx4 v[148:151], v3, s[28:31], s36 offen nt
s_waitcnt vmcnt(1)
buffer_load_dwordx4 v[212:215], v126, s[28:31], s36 offen nt
s_add_u32 s36, s36, 131072
s_waitcnt vmcnt(1)
buffer_load_dwordx4 v[152:155], v3, s[28:31], s36 offen nt
s_waitcnt vmcnt(1)
buffer_load_dwordx4 v[216:219], v126, s[28:31], s36 offen nt
s_add_u32 s36, s36, 131072
s_waitcnt vmcnt(1)
buffer_load_dwordx4 v[156:159], v3, s[28:31], s36 offen nt
s_waitcnt vmcnt(1)
buffer_load_dwordx4 v[220:223], v126, s[28:31], s36 offen nt
s_add_u32 s36, s36, 131072
s_waitcnt vmcnt(1)
buffer_load_dwordx4 v[160:163], v3, s[28:31], s36 offen nt
s_waitcnt vmcnt(1)
buffer_load_dwordx4 v[224:227], v126, s[28:31], s36 offen nt
s_add_u32 s36, s36, 131072
s_waitcnt vmcnt(1)
buffer_load_dwordx4 v[164:167], v3, s[28:31], s36 offen nt
s_waitcnt vmcnt(1)
buffer_load_dwordx4 v[228:231], v126, s[28:31], s36 offen nt
s_add_u32 s36, s36, 131072
s_waitcnt vmcnt(1)
buffer_load_dwordx4 v[168:171], v3, s[28:31], s36 offen nt
s_waitcnt vmcnt(1)
buffer_load_dwordx4 v[232:235], v126, s[28:31], s36 offen nt
s_add_u32 s36, s36, 131072
s_waitcnt vmcnt(1)
buffer_load_dwordx4 v[172:175], v3, s[28:31], s36 offen nt
s_waitcnt vmcnt(1)
buffer_load_dwordx4 v[236:239], v126, s[28:31], s36 offen nt
s_add_u32 s36, s36, 131072
s_waitcnt vmcnt(1)
buffer_load_dwordx4 v[176:179], v3, s[28:31], s36 offen nt
s_waitcnt vmcnt(1)
buffer_load_dwordx4 v[240:243], v126, s[28:31], s36 offen nt
s_add_u32 s36, s36, 131072
s_waitcnt vmcnt(1)
buffer_load_dwordx4 v[180:183], v3, s[28:31], s36 offen nt
s_waitcnt vmcnt(1)
buffer_load_dwordx4 v[244:247], v126, s[28:31], s36 offen nt
s_add_u32 s36, s36, 131072
s_waitcnt vmcnt(1)
buffer_load_dwordx4 v[184:187], v3, s[28:31], s36 offen nt
s_waitcnt vmcnt(1)
buffer_load_dwordx4 v[248:251], v126, s[28:31], s36 offen nt
s_add_u32 s36, s36, 131072
s_waitcnt vmcnt(1)
buffer_load_dwordx4 v[188:191], v3, s[28:31], s36 offen nt
s_waitcnt vmcnt(1)
buffer_load_dwordx4 v[252:255], v126, s[28:31], s36 offen nt
s_add_u32 s36, s36, 131072
v_readfirstlane_b32 s56, v20
s_nop 0
s_add_u32 s56, s56, 0x01010101
s_bfe_u32 s43, s56, 524288
v_mov_b32 v20, s43
s_bfe_u32 s43, s56, 524296
v_mov_b32 v21, s43
s_bfe_u32 s43, s56, 524304
v_mov_b32 v22, s43
s_bfe_u32 s43, s56, 524312
v_mov_b32 v23, s43
v_mov_b32 v8, s56
ds_write_b32 v6, v8 offset:88
s_mov_b32 s57, 0xffffff00
s_mov_b32 s58, 0x0c0c0400
s_mov_b32 s59, 0x04000c0c
s_mul_i32 s36, s22, 33024
v_mul_u32_u24 v10, 2064, v5
v_lshl_add_u32 v10, v4, 4, v10
v_add_u32 v10, s36, v10
v_and_b32 v8, 1, v0
v_mul_u32_u24 v11, 2112, v8
v_bfe_u32 v8, v0, 1, 1
v_mul_u32_u24 v8, 4224, v8
v_add_u32 v11, v11, v8
v_lshl_add_u32 v11, v4, 4, v11
v_add_u32 v11, 132096, v11
v_bfe_u32 v8, v0, 3, 1
v_lshlrev_b32 v12, 8, v8
v_lshl_add_u32 v12, v4, 6, v12
v_add_u32 v12, 158208, v12
v_and_b32 v8, 7, v0
v_lshlrev_b32 v13, 2, v8
v_lshl_add_u32 v13, v4, 7, v13
s_lshl_b32 s36, s22, 10
v_add_u32 v13, s36, v13
v_add_u32 v13, 132096, v13
v_and_b32 v9, 1, v0
v_lshlrev_b32 v9, 4, v9
v_mov_b32 v14, 0xffff
v_lshlrev_b32 v9, v9, v14
v_bfe_u32 v8, v0, 1, 2
v_cmp_eq_u32 vcc, 0, v8
s_nop 1
v_cndmask_b32 v16, 0, v9, vcc
v_cmp_eq_u32 vcc, 1, v8
s_nop 1
v_cndmask_b32 v17, 0, v9, vcc
v_cmp_eq_u32 vcc, 2, v8
s_nop 1
v_cndmask_b32 v18, 0, v9, vcc
v_cmp_eq_u32 vcc, 3, v8
s_nop 1
v_cndmask_b32 v19, 0, v9, vcc
s_and_b32 s60, s21, 7
s_lshl_b32 s60, s60, 12
s_lshr_b32 s61, s21, 3
s_lshl_b32 s61, s61, 18
s_add_u32 s60, s60, s61
s_lshl_b32 s61, s20, 8
s_add_u32 s61, s61, s60
v_lshlrev_b32 v120, 15, v4
v_lshl_add_u32 v120, v5, 4, v120
v_and_b32 v121, 33023, v120
s_mov_b32 s46, 0x40000
L_w6:
ds_read_b32 v8, v6 offset:0
s_waitcnt lgkmcnt(0)
v_readfirstlane_b32 s43, v8
s_nop 0
s_cmp_ge_u32 s43, 4
s_cbranch_scc1 L_wd7
s_sub_u32 s46, s46, 1
s_cbranch_scc1 L_wd7
s_sleep 16
s_branch L_w6
L_wd7:
s_mov_b32 s46, 0x40000
L_w8:
ds_read_b32 v8, v6 offset:4
s_waitcnt lgkmcnt(0)
v_readfirstlane_b32 s43, v8
s_nop 0
s_cmp_ge_u32 s43, 4
s_cbranch_scc1 L_wd9
s_sub_u32 s46, s46, 1
s_cbranch_scc1 L_wd9
s_sleep 16
s_branch L_w8
L_wd9:
v_mov_b32 v24, 0
v_mov_b32 v25, 0
v_mov_b32 v26, 0
v_mov_b32 v27, 0
ds_read_b128 v[56:59], v10 offset:0
ds_read_b128 v[60:63], v11 offset:0
ds_read_b128 v[64:67], v10 offset:64
ds_read_b128 v[68:71], v11 offset:64
ds_read_b128 v[72:75], v10 offset:128
ds_read_b128 v[76:79], v11 offset:128
ds_read_b128 v[80:83], v10 offset:192
ds_read_b128 v[84:87], v11 offset:192
s_waitcnt lgkmcnt(6)
v_mfma_f32_16x16x32_bf16 v[24:27], v[56:59], v[60:63], v[24:27]
s_waitcnt lgkmcnt(4)
v_mfma_f32_16x16x32_bf16 v[24:27], v[64:67], v[68:71], v[24:27]
s_waitcnt lgkmcnt(2)
v_mfma_f32_16x16x32_bf16 v[24:27], v[72:75], v[76:79], v[24:27]
s_waitcnt lgkmcnt(0)
v_mfma_f32_16x16x32_bf16 v[24:27], v[80:83], v[84:87], v[24:27]
ds_read_b128 v[56:59], v10 offset:256
ds_read_b128 v[60:63], v11 offset:256
ds_read_b128 v[64:67], v10 offset:320
ds_read_b128 v[68:71], v11 offset:320
ds_read_b128 v[72:75], v10 offset:384
ds_read_b128 v[76:79], v11 offset:384
ds_read_b128 v[80:83], v10 offset:448
ds_read_b128 v[84:87], v11 offset:448
s_waitcnt lgkmcnt(6)
v_mfma_f32_16x16x32_bf16 v[24:27], v[56:59], v[60:63], v[24:27]
s_waitcnt lgkmcnt(4)
v_mfma_f32_16x16x32_bf16 v[24:27], v[64:67], v[68:71], v[24:27]
s_waitcnt lgkmcnt(2)
v_mfma_f32_16x16x32_bf16 v[24:27], v[72:75], v[76:79], v[24:27]
s_waitcnt lgkmcnt(0)
v_mfma_f32_16x16x32_bf16 v[24:27], v[80:83], v[84:87], v[24:27]
ds_read_b128 v[56:59], v10 offset:512
ds_read_b128 v[60:63], v11 offset:512
ds_read_b128 v[64:67], v10 offset:576
ds_read_b128 v[68:71], v11 offset:576
ds_read_b128 v[72:75], v10 offset:640
ds_read_b128 v[76:79], v11 offset:640
ds_read_b128 v[80:83], v10 offset:704
ds_read_b128 v[84:87], v11 offset:704
s_waitcnt lgkmcnt(6)
v_mfma_f32_16x16x32_bf16 v[24:27], v[56:59], v[60:63], v[24:27]
s_waitcnt lgkmcnt(4)
v_mfma_f32_16x16x32_bf16 v[24:27], v[64:67], v[68:71], v[24:27]
s_waitcnt lgkmcnt(2)
v_mfma_f32_16x16x32_bf16 v[24:27], v[72:75], v[76:79], v[24:27]
s_waitcnt lgkmcnt(0)
v_mfma_f32_16x16x32_bf16 v[24:27], v[80:83], v[84:87], v[24:27]
ds_read_b128 v[56:59], v10 offset:768
ds_read_b128 v[60:63], v11 offset:768
ds_read_b128 v[64:67], v10 offset:832
ds_read_b128 v[68:71], v11 offset:832
ds_read_b128 v[72:75], v10 offset:896
ds_read_b128 v[76:79], v11 offset:896
ds_read_b128 v[80:83], v10 offset:960
ds_read_b128 v[84:87], v11 offset:960
s_waitcnt lgkmcnt(6)
v_mfma_f32_16x16x32_bf16 v[24:27], v[56:59], v[60:63], v[24:27]
s_waitcnt lgkmcnt(4)
v_mfma_f32_16x16x32_bf16 v[24:27], v[64:67], v[68:71], v[24:27]
s_waitcnt lgkmcnt(2)
v_mfma_f32_16x16x32_bf16 v[24:27], v[72:75], v[76:79], v[24:27]
s_waitcnt lgkmcnt(0)
v_mfma_f32_16x16x32_bf16 v[24:27], v[80:83], v[84:87], v[24:27]
ds_read_b128 v[56:59], v10 offset:1024
ds_read_b128 v[60:63], v11 offset:1024
ds_read_b128 v[64:67], v10 offset:1088
ds_read_b128 v[68:71], v11 offset:1088
ds_read_b128 v[72:75], v10 offset:1152
ds_read_b128 v[76:79], v11 offset:1152
ds_read_b128 v[80:83], v10 offset:1216
ds_read_b128 v[84:87], v11 offset:1216
s_waitcnt lgkmcnt(6)
v_mfma_f32_16x16x32_bf16 v[24:27], v[56:59], v[60:63], v[24:27]
s_waitcnt lgkmcnt(4)
v_mfma_f32_16x16x32_bf16 v[24:27], v[64:67], v[68:71], v[24:27]
s_waitcnt lgkmcnt(2)
v_mfma_f32_16x16x32_bf16 v[24:27], v[72:75], v[76:79], v[24:27]
s_waitcnt lgkmcnt(0)
v_mfma_f32_16x16x32_bf16 v[24:27], v[80:83], v[84:87], v[24:27]
ds_read_b128 v[56:59], v10 offset:1280
ds_read_b128 v[60:63], v11 offset:1280
ds_read_b128 v[64:67], v10 offset:1344
ds_read_b128 v[68:71], v11 offset:1344
ds_read_b128 v[72:75], v10 offset:1408
ds_read_b128 v[76:79], v11 offset:1408
ds_read_b128 v[80:83], v10 offset:1472
ds_read_b128 v[84:87], v11 offset:1472
s_waitcnt lgkmcnt(6)
v_mfma_f32_16x16x32_bf16 v[24:27], v[56:59], v[60:63], v[24:27]
s_waitcnt lgkmcnt(4)
v_mfma_f32_16x16x32_bf16 v[24:27], v[64:67], v[68:71], v[24:27]
s_waitcnt lgkmcnt(2)
v_mfma_f32_16x16x32_bf16 v[24:27], v[72:75], v[76:79], v[24:27]
s_waitcnt lgkmcnt(0)
v_mfma_f32_16x16x32_bf16 v[24:27], v[80:83], v[84:87], v[24:27]
ds_read_b128 v[56:59], v10 offset:1536
ds_read_b128 v[60:63], v11 offset:1536
ds_read_b128 v[64:67], v10 offset:1600
ds_read_b128 v[68:71], v11 offset:1600
ds_read_b128 v[72:75], v10 offset:1664
ds_read_b128 v[76:79], v11 offset:1664
ds_read_b128 v[80:83], v10 offset:1728
ds_read_b128 v[84:87], v11 offset:1728
s_waitcnt lgkmcnt(6)
v_mfma_f32_16x16x32_bf16 v[24:27], v[56:59], v[60:63], v[24:27]
s_waitcnt lgkmcnt(4)
v_mfma_f32_16x16x32_bf16 v[24:27], v[64:67], v[68:71], v[24:27]
s_waitcnt lgkmcnt(2)
v_mfma_f32_16x16x32_bf16 v[24:27], v[72:75], v[76:79], v[24:27]
s_waitcnt lgkmcnt(0)
v_mfma_f32_16x16x32_bf16 v[24:27], v[80:83], v[84:87], v[24:27]
ds_read_b128 v[56:59], v10 offset:1792
ds_read_b128 v[60:63], v11 offset:1792
ds_read_b128 v[64:67], v10 offset:1856
ds_read_b128 v[68:71], v11 offset:1856
ds_read_b128 v[72:75], v10 offset:1920
ds_read_b128 v[76:79], v11 offset:1920
ds_read_b128 v[80:83], v10 offset:1984
ds_read_b128 v[84:87], v11 offset:1984
s_waitcnt lgkmcnt(6)
v_mfma_f32_16x16x32_bf16 v[24:27], v[56:59], v[60:63], v[24:27]
s_waitcnt lgkmcnt(4)
v_mfma_f32_16x16x32_bf16 v[24:27], v[64:67], v[68:71], v[24:27]
s_waitcnt lgkmcnt(2)
v_mfma_f32_16x16x32_bf16 v[24:27], v[72:75], v[76:79], v[24:27]
s_waitcnt lgkmcnt(0)
v_mfma_f32_16x16x32_bf16 v[24:27], v[80:83], v[84:87], v[24:27]
s_lshl_b32 s36, s22, 6
v_bfe_u32 v9, v0, 1, 1
v_lshlrev_b32 v8, 4, v4
v_lshl_add_u32 v8, v9, 8, v8
v_add_u32 v8, s36, v8
v_add_u32 v8, 157184, v8
s_nop 4
v_add_f32_dpp v28, v24, v24 quad_perm:[1,0,3,2] row_mask:0xf bank_mask:0xf
v_add_f32_dpp v29, v25, v25 quad_perm:[1,0,3,2] row_mask:0xf bank_mask:0xf
v_add_f32_dpp v30, v26, v26 quad_perm:[1,0,3,2] row_mask:0xf bank_mask:0xf
v_add_f32_dpp v31, v27, v27 quad_perm:[1,0,3,2] row_mask:0xf bank_mask:0xf
ds_write_b128 v8, v[28:31]
s_mov_b64 exec, 1
ds_add_rtn_u32 v8, v6, v7 offset:32
s_mov_b64 exec, -1
s_waitcnt lgkmcnt(0)
v_readfirstlane_b32 s43, v8
s_nop 0
s_cmp_lg_u32 s43, 3
s_cbranch_scc1 L_nopub10
v_add_u32 v9, 157184, v2
s_mov_b32 exec_hi, 0
ds_read_b128 v[56:59], v9
s_add_u32 s37, s61, 524288
s_waitcnt lgkmcnt(0)
v_and_or_b32 v56, v56, s57, v20
v_and_or_b32 v57, v57, s57, v21
v_and_or_b32 v58, v58, s57, v22
v_and_or_b32 v59, v59, s57, v23
buffer_store_dwordx4 v[56:59], v120, s[32:35], s37 offen sc1
s_mov_b64 exec, -1
s_nop 1
L_nopub10:
s_cmp_lg_u32 s22, 0
s_cbranch_scc1 L_nop11
s_add_u32 s39, s47, 1572864
s_add_u32 s43, s21, 0
s_and_b32 s43, s43, 15
s_cmp_lg_u32 s43, s20
s_cbranch_scc1 L_oth12
s_mov_b32 s46, 0x40000
L_w14:
ds_read_b32 v8, v6 offset:80
s_waitcnt lgkmcnt(0)
v_readfirstlane_b32 s43, v8
s_nop 0
s_cmp_ge_u32 s43, 24
s_cbranch_scc1 L_wd15
s_sub_u32 s46, s46, 1
s_cbranch_scc1 L_wd15
s_sleep 16
s_branch L_w14
L_wd15:
s_add_u32 s37, s60, 524288
v_lshrrev_b32 v3, 5, v0
v_lshl_add_u32 v3, v3, 8, v121
s_mov_b32 s46, 32768
L_gp16:
buffer_load_dwordx4 v[56:59], v3, s[32:35], s37 offen offset:0 sc1
buffer_load_dwordx4 v[60:63], v3, s[32:35], s37 offen offset:512 sc1
buffer_load_dwordx4 v[64:67], v3, s[32:35], s37 offen offset:1024 sc1
buffer_load_dwordx4 v[68:71], v3, s[32:35], s37 offen offset:1536 sc1
buffer_load_dwordx4 v[72:75], v3, s[32:35], s37 offen offset:2048 sc1
buffer_load_dwordx4 v[76:79], v3, s[32:35], s37 offen offset:2560 sc1
buffer_load_dwordx4 v[80:83], v3, s[32:35], s37 offen offset:3072 sc1
buffer_load_dwordx4 v[84:87], v3, s[32:35], s37 offen offset:3584 sc1
s_mov_b64 s[62:63], 0
s_waitcnt vmcnt(7)
v_perm_b32 v8, v57, v56, s58
v_perm_b32 v9, v59, v58, s59
v_or_b32 v8, v8, v9
v_cmp_ne_u32 vcc, s56, v8
s_or_b64 s[62:63], s[62:63], vcc
s_waitcnt vmcnt(6)
v_perm_b32 v8, v61, v60, s58
v_perm_b32 v9, v63, v62, s59
v_or_b32 v8, v8, v9
v_cmp_ne_u32 vcc, s56, v8
s_or_b64 s[62:63], s[62:63], vcc
s_waitcnt vmcnt(5)
v_perm_b32 v8, v65, v64, s58
v_perm_b32 v9, v67, v66, s59
v_or_b32 v8, v8, v9
v_cmp_ne_u32 vcc, s56, v8
s_or_b64 s[62:63], s[62:63], vcc
s_waitcnt vmcnt(4)
v_perm_b32 v8, v69, v68, s58
v_perm_b32 v9, v71, v70, s59
v_or_b32 v8, v8, v9
v_cmp_ne_u32 vcc, s56, v8
s_or_b64 s[62:63], s[62:63], vcc
s_waitcnt vmcnt(3)
v_perm_b32 v8, v73, v72, s58
v_perm_b32 v9, v75, v74, s59
v_or_b32 v8, v8, v9
v_cmp_ne_u32 vcc, s56, v8
s_or_b64 s[62:63], s[62:63], vcc
s_waitcnt vmcnt(2)
v_perm_b32 v8, v77, v76, s58
v_perm_b32 v9, v79, v78, s59
v_or_b32 v8, v8, v9
v_cmp_ne_u32 vcc, s56, v8
s_or_b64 s[62:63], s[62:63], vcc
s_waitcnt vmcnt(1)
v_perm_b32 v8, v81, v80, s58
v_perm_b32 v9, v83, v82, s59
v_or_b32 v8, v8, v9
v_cmp_ne_u32 vcc, s56, v8
s_or_b64 s[62:63], s[62:63], vcc
s_waitcnt vmcnt(0)
v_perm_b32 v8, v85, v84, s58
v_perm_b32 v9, v87, v86, s59
v_or_b32 v8, v8, v9
v_cmp_ne_u32 vcc, s56, v8
s_or_b64 s[62:63], s[62:63], vcc
s_cmp_eq_u64 s[62:63], 0
s_cbranch_scc1 L_gpd17
s_sub_u32 s46, s46, 1
s_cbranch_scc1 L_gpd17
s_sleep 8
s_branch L_gp16
L_gpd17:
v_and_b32 v56, s57, v56
v_and_b32 v57, s57, v57
v_and_b32 v58, s57, v58
v_and_b32 v59, s57, v59
v_and_b32 v60, s57, v60
v_and_b32 v61, s57, v61
v_and_b32 v62, s57, v62
v_and_b32 v63, s57, v63
v_and_b32 v64, s57, v64
v_and_b32 v65, s57, v65
v_and_b32 v66, s57, v66
v_and_b32 v67, s57, v67
v_and_b32 v68, s57, v68
v_and_b32 v69, s57, v69
v_and_b32 v70, s57, v70
v_and_b32 v71, s57, v71
v_and_b32 v72, s57, v72
v_and_b32 v73, s57, v73
v_and_b32 v74, s57, v74
v_and_b32 v75, s57, v75
v_and_b32 v76, s57, v76
v_and_b32 v77, s57, v77
v_and_b32 v78, s57, v78
v_and_b32 v79, s57, v79
v_and_b32 v80, s57, v80
v_and_b32 v81, s57, v81
v_and_b32 v82, s57, v82
v_and_b32 v83, s57, v83
v_and_b32 v84, s57, v84
v_and_b32 v85, s57, v85
v_and_b32 v86, s57, v86
v_and_b32 v87, s57, v87
v_add_f32 v56, v56, v72
v_add_f32 v57, v57, v73
v_add_f32 v58, v58, v74
v_add_f32 v59, v59, v75
v_add_f32 v60, v60, v76
v_add_f32 v61, v61, v77
v_add_f32 v62, v62, v78
v_add_f32 v63, v63, v79
v_add_f32 v64, v64, v80
v_add_f32 v65, v65, v81
v_add_f32 v66, v66, v82
v_add_f32 v67, v67, v83
v_add_f32 v68, v68, v84
v_add_f32 v69, v69, v85
v_add_f32 v70, v70, v86
v_add_f32 v71, v71, v87
v_add_f32 v56, v56, v64
v_add_f32 v57, v57, v65
v_add_f32 v58, v58, v66
v_add_f32 v59, v59, v67
v_add_f32 v60, v60, v68
v_add_f32 v61, v61, v69
v_add_f32 v62, v62, v70
v_add_f32 v63, v63, v71
v_add_f32 v56, v56, v60
v_add_f32 v57, v57, v61
v_add_f32 v58, v58, v62
v_add_f32 v59, v59, v63
v_mov_b32 v60, v56
v_mov_b32 v61, v57
v_mov_b32 v62, v58
v_mov_b32 v63, v59
s_nop 1
v_permlane32_swap_b32 v56, v60
v_permlane32_swap_b32 v57, v61
v_permlane32_swap_b32 v58, v62
v_permlane32_swap_b32 v59, v63
v_add_f32 v56, v56, v60
v_add_f32 v57, v57, v61
v_add_f32 v58, v58, v62
v_add_f32 v59, v59, v63
v_max_f32 v60, v56, v57
v_max3_f32 v60, v60, v58, v59
s_nop 1
v_max_f32_dpp v60, v60, v60 row_ror:8 row_mask:0xf bank_mask:0xf
s_nop 1
v_max_f32_dpp v60, v60, v60 row_ror:4 row_mask:0xf bank_mask:0xf
s_nop 1
v_max_f32_dpp v60, v60, v60 row_ror:2 row_mask:0xf bank_mask:0xf
s_nop 1
v_max_f32_dpp v60, v60, v60 row_ror:1 row_mask:0xf bank_mask:0xf
s_mov_b32 s36, 0x3e0293ee
v_sub_f32 v56, v56, v60
v_mul_f32 v56, s36, v56
v_exp_f32 v56, v56
v_sub_f32 v57, v57, v60
v_mul_f32 v57, s36, v57
v_exp_f32 v57, v57
v_sub_f32 v58, v58, v60
v_mul_f32 v58, s36, v58
v_exp_f32 v58, v58
v_sub_f32 v59, v59, v60
v_mul_f32 v59, s36, v59
v_exp_f32 v59, v59
s_nop 0
v_add_f32 v60, v56, v57
v_add_f32 v61, v58, v59
v_add_f32 v60, v60, v61
s_nop 1
v_add_f32_dpp v60, v60, v60 row_ror:8 row_mask:0xf bank_mask:0xf
s_nop 1
v_add_f32_dpp v60, v60, v60 row_ror:4 row_mask:0xf bank_mask:0xf
s_nop 1
v_add_f32_dpp v60, v60, v60 row_ror:2 row_mask:0xf bank_mask:0xf
s_nop 1
v_add_f32_dpp v60, v60, v60 row_ror:1 row_mask:0xf bank_mask:0xf
v_rcp_f32 v60, v60
s_nop 0
v_mul_f32 v56, v56, v60
v_mul_f32 v57, v57, v60
v_mul_f32 v58, v58, v60
v_mul_f32 v59, v59, v60
v_and_or_b32 v56, v56, s57, v20
v_and_or_b32 v57, v57, s57, v21
v_and_or_b32 v58, v58, s57, v22
v_and_or_b32 v59, v59, s57, v23
s_mov_b32 exec_hi, 0
buffer_store_dwordx4 v[56:59], v120, s[32:35], s39 offen sc1
s_mov_b64 exec, -1
s_branch L_com13
L_oth12:
s_mov_b32 s46, 0x40000
L_w18:
ds_read_b32 v8, v6 offset:80
s_waitcnt lgkmcnt(0)
v_readfirstlane_b32 s43, v8
s_nop 0
s_cmp_ge_u32 s43, 27
s_cbranch_scc1 L_wd19
s_sub_u32 s46, s46, 1
s_cbranch_scc1 L_wd19
s_sleep 16
s_branch L_w18
L_wd19:
s_mov_b32 s46, 32768
L_pp20:
buffer_load_dwordx4 v[56:59], v121, s[32:35], s39 offen sc1
s_waitcnt vmcnt(0)
v_perm_b32 v8, v57, v56, s58
v_perm_b32 v9, v59, v58, s59
v_or_b32 v8, v8, v9
v_cmp_ne_u32 vcc, s56, v8
s_cmp_eq_u64 vcc, 0
s_cbranch_scc1 L_com13
s_sub_u32 s46, s46, 1
s_cbranch_scc1 L_com13
s_sleep 8
s_branch L_pp20
L_com13:
v_lshrrev_b32 v8, 5, v0
v_sub_u32 v9, 0, v8
v_and_b32 v9, 0xffff0000, v9
v_mov_b32 v14, 0x03020302
v_and_b32 v60, s57, v56
v_and_b32 v64, v60, v9
v_sub_f32 v60, v60, v64
v_perm_b32 v60, v60, v60, v14
v_and_b32 v61, s57, v57
v_and_b32 v64, v61, v9
v_sub_f32 v61, v61, v64
v_perm_b32 v61, v61, v61, v14
v_and_b32 v62, s57, v58
v_and_b32 v64, v62, v9
v_sub_f32 v62, v62, v64
v_perm_b32 v62, v62, v62, v14
v_and_b32 v63, s57, v59
v_and_b32 v64, v63, v9
v_sub_f32 v63, v63, v64
v_perm_b32 v63, v63, v63, v14
v_lshlrev_b32 v8, 8, v8
v_lshl_add_u32 v8, v5, 2, v8
v_and_b32 v9, 1, v4
v_lshl_add_u32 v8, v9, 9, v8
v_add_u32 v8, 158208, v8
ds_write_b32 v8, v60 offset:0
ds_write_b32 v8, v61 offset:64
ds_write_b32 v8, v62 offset:128
ds_write_b32 v8, v63 offset:192
s_mov_b64 exec, 1
ds_add_u32 v6, v7 offset:48
s_mov_b64 exec, -1
L_nop11:
s_mov_b32 s46, 0x40000
L_w21:
ds_read_b32 v8, v6 offset:48
s_waitcnt lgkmcnt(0)
v_readfirstlane_b32 s43, v8
s_nop 0
s_cmp_ge_u32 s43, 1
s_cbranch_scc1 L_wd22
s_sub_u32 s46, s46, 1
s_cbranch_scc1 L_wd22
s_sleep 16
s_branch L_w21
L_wd22:
ds_read_b128 v[88:91], v12 offset:0
ds_read_b128 v[92:95], v12 offset:16
ds_read_b128 v[96:99], v12 offset:32
ds_read_b128 v[100:103], v12 offset:48
ds_read_b128 v[104:107], v12 offset:512
ds_read_b128 v[108:111], v12 offset:528
ds_read_b128 v[112:115], v12 offset:544
ds_read_b128 v[116:119], v12 offset:560
v_mov_b32 v24, 0
v_mov_b32 v25, 0
v_mov_b32 v26, 0
v_mov_b32 v27, 0
v_mov_b32 v28, 0
v_mov_b32 v29, 0
v_mov_b32 v30, 0
v_mov_b32 v31, 0
v_mov_b32 v32, 0
v_mov_b32 v33, 0
v_mov_b32 v34, 0
v_mov_b32 v35, 0
v_mov_b32 v36, 0
v_mov_b32 v37, 0
v_mov_b32 v38, 0
v_mov_b32 v39, 0
s_waitcnt vmcnt(0) lgkmcnt(0)
v_and_b32 v40, v88, v16
v_and_b32 v41, v88, v17
v_and_b32 v42, v88, v18
v_and_b32 v43, v88, v19
v_and_b32 v44, v104, v16
v_and_b32 v45, v104, v17
v_and_b32 v46, v104, v18
v_and_b32 v47, v104, v19
s_nop 0
v_mfma_f32_16x16x32_bf16 v[24:27], v[128:131], v[40:43], v[24:27]
v_mfma_f32_16x16x32_bf16 v[28:31], v[192:195], v[40:43], v[28:31]
v_mfma_f32_16x16x32_bf16 v[32:35], v[128:131], v[44:47], v[32:35]
v_mfma_f32_16x16x32_bf16 v[36:39], v[192:195], v[44:47], v[36:39]
v_and_b32 v48, v89, v16
v_and_b32 v49, v89, v17
v_and_b32 v50, v89, v18
v_and_b32 v51, v89, v19
v_and_b32 v52, v105, v16
v_and_b32 v53, v105, v17
v_and_b32 v54, v105, v18
v_and_b32 v55, v105, v19
s_nop 0
v_mfma_f32_16x16x32_bf16 v[24:27], v[132:135], v[48:51], v[24:27]
v_mfma_f32_16x16x32_bf16 v[28:31], v[196:199], v[48:51], v[28:31]
v_mfma_f32_16x16x32_bf16 v[32:35], v[132:135], v[52:55], v[32:35]
v_mfma_f32_16x16x32_bf16 v[36:39], v[196:199], v[52:55], v[36:39]
v_and_b32 v40, v90, v16
v_and_b32 v41, v90, v17
v_and_b32 v42, v90, v18
v_and_b32 v43, v90, v19
v_and_b32 v44, v106, v16
v_and_b32 v45, v106, v17
v_and_b32 v46, v106, v18
v_and_b32 v47, v106, v19
s_nop 0
v_mfma_f32_16x16x32_bf16 v[24:27], v[136:139], v[40:43], v[24:27]
v_mfma_f32_16x16x32_bf16 v[28:31], v[200:203], v[40:43], v[28:31]
v_mfma_f32_16x16x32_bf16 v[32:35], v[136:139], v[44:47], v[32:35]
v_mfma_f32_16x16x32_bf16 v[36:39], v[200:203], v[44:47], v[36:39]
v_and_b32 v48, v91, v16
v_and_b32 v49, v91, v17
v_and_b32 v50, v91, v18
v_and_b32 v51, v91, v19
v_and_b32 v52, v107, v16
v_and_b32 v53, v107, v17
v_and_b32 v54, v107, v18
v_and_b32 v55, v107, v19
s_nop 0
v_mfma_f32_16x16x32_bf16 v[24:27], v[140:143], v[48:51], v[24:27]
v_mfma_f32_16x16x32_bf16 v[28:31], v[204:207], v[48:51], v[28:31]
v_mfma_f32_16x16x32_bf16 v[32:35], v[140:143], v[52:55], v[32:35]
v_mfma_f32_16x16x32_bf16 v[36:39], v[204:207], v[52:55], v[36:39]
v_and_b32 v40, v92, v16
v_and_b32 v41, v92, v17
v_and_b32 v42, v92, v18
v_and_b32 v43, v92, v19
v_and_b32 v44, v108, v16
v_and_b32 v45, v108, v17
v_and_b32 v46, v108, v18
v_and_b32 v47, v108, v19
s_nop 0
v_mfma_f32_16x16x32_bf16 v[24:27], v[144:147], v[40:43], v[24:27]
v_mfma_f32_16x16x32_bf16 v[28:31], v[208:211], v[40:43], v[28:31]
v_mfma_f32_16x16x32_bf16 v[32:35], v[144:147], v[44:47], v[32:35]
v_mfma_f32_16x16x32_bf16 v[36:39], v[208:211], v[44:47], v[36:39]
v_and_b32 v48, v93, v16
v_and_b32 v49, v93, v17
v_and_b32 v50, v93, v18
v_and_b32 v51, v93, v19
v_and_b32 v52, v109, v16
v_and_b32 v53, v109, v17
v_and_b32 v54, v109, v18
v_and_b32 v55, v109, v19
s_nop 0
v_mfma_f32_16x16x32_bf16 v[24:27], v[148:151], v[48:51], v[24:27]
v_mfma_f32_16x16x32_bf16 v[28:31], v[212:215], v[48:51], v[28:31]
v_mfma_f32_16x16x32_bf16 v[32:35], v[148:151], v[52:55], v[32:35]
v_mfma_f32_16x16x32_bf16 v[36:39], v[212:215], v[52:55], v[36:39]
v_and_b32 v40, v94, v16
v_and_b32 v41, v94, v17
v_and_b32 v42, v94, v18
v_and_b32 v43, v94, v19
v_and_b32 v44, v110, v16
v_and_b32 v45, v110, v17
v_and_b32 v46, v110, v18
v_and_b32 v47, v110, v19
s_nop 0
v_mfma_f32_16x16x32_bf16 v[24:27], v[152:155], v[40:43], v[24:27]
v_mfma_f32_16x16x32_bf16 v[28:31], v[216:219], v[40:43], v[28:31]
v_mfma_f32_16x16x32_bf16 v[32:35], v[152:155], v[44:47], v[32:35]
v_mfma_f32_16x16x32_bf16 v[36:39], v[216:219], v[44:47], v[36:39]
v_and_b32 v48, v95, v16
v_and_b32 v49, v95, v17
v_and_b32 v50, v95, v18
v_and_b32 v51, v95, v19
v_and_b32 v52, v111, v16
v_and_b32 v53, v111, v17
v_and_b32 v54, v111, v18
v_and_b32 v55, v111, v19
s_nop 0
v_mfma_f32_16x16x32_bf16 v[24:27], v[156:159], v[48:51], v[24:27]
v_mfma_f32_16x16x32_bf16 v[28:31], v[220:223], v[48:51], v[28:31]
v_mfma_f32_16x16x32_bf16 v[32:35], v[156:159], v[52:55], v[32:35]
v_mfma_f32_16x16x32_bf16 v[36:39], v[220:223], v[52:55], v[36:39]
v_and_b32 v40, v96, v16
v_and_b32 v41, v96, v17
v_and_b32 v42, v96, v18
v_and_b32 v43, v96, v19
v_and_b32 v44, v112, v16
v_and_b32 v45, v112, v17
v_and_b32 v46, v112, v18
v_and_b32 v47, v112, v19
s_nop 0
v_mfma_f32_16x16x32_bf16 v[24:27], v[160:163], v[40:43], v[24:27]
v_mfma_f32_16x16x32_bf16 v[28:31], v[224:227], v[40:43], v[28:31]
v_mfma_f32_16x16x32_bf16 v[32:35], v[160:163], v[44:47], v[32:35]
v_mfma_f32_16x16x32_bf16 v[36:39], v[224:227], v[44:47], v[36:39]
v_and_b32 v48, v97, v16
v_and_b32 v49, v97, v17
v_and_b32 v50, v97, v18
v_and_b32 v51, v97, v19
v_and_b32 v52, v113, v16
v_and_b32 v53, v113, v17
v_and_b32 v54, v113, v18
v_and_b32 v55, v113, v19
s_nop 0
v_mfma_f32_16x16x32_bf16 v[24:27], v[164:167], v[48:51], v[24:27]
v_mfma_f32_16x16x32_bf16 v[28:31], v[228:231], v[48:51], v[28:31]
v_mfma_f32_16x16x32_bf16 v[32:35], v[164:167], v[52:55], v[32:35]
v_mfma_f32_16x16x32_bf16 v[36:39], v[228:231], v[52:55], v[36:39]
v_and_b32 v40, v98, v16
v_and_b32 v41, v98, v17
v_and_b32 v42, v98, v18
v_and_b32 v43, v98, v19
v_and_b32 v44, v114, v16
v_and_b32 v45, v114, v17
v_and_b32 v46, v114, v18
v_and_b32 v47, v114, v19
s_nop 0
v_mfma_f32_16x16x32_bf16 v[24:27], v[168:171], v[40:43], v[24:27]
v_mfma_f32_16x16x32_bf16 v[28:31], v[232:235], v[40:43], v[28:31]
v_mfma_f32_16x16x32_bf16 v[32:35], v[168:171], v[44:47], v[32:35]
v_mfma_f32_16x16x32_bf16 v[36:39], v[232:235], v[44:47], v[36:39]
v_and_b32 v48, v99, v16
v_and_b32 v49, v99, v17
v_and_b32 v50, v99, v18
v_and_b32 v51, v99, v19
v_and_b32 v52, v115, v16
v_and_b32 v53, v115, v17
v_and_b32 v54, v115, v18
v_and_b32 v55, v115, v19
s_nop 0
v_mfma_f32_16x16x32_bf16 v[24:27], v[172:175], v[48:51], v[24:27]
v_mfma_f32_16x16x32_bf16 v[28:31], v[236:239], v[48:51], v[28:31]
v_mfma_f32_16x16x32_bf16 v[32:35], v[172:175], v[52:55], v[32:35]
v_mfma_f32_16x16x32_bf16 v[36:39], v[236:239], v[52:55], v[36:39]
v_and_b32 v40, v100, v16
v_and_b32 v41, v100, v17
v_and_b32 v42, v100, v18
v_and_b32 v43, v100, v19
v_and_b32 v44, v116, v16
v_and_b32 v45, v116, v17
v_and_b32 v46, v116, v18
v_and_b32 v47, v116, v19
s_nop 0
v_mfma_f32_16x16x32_bf16 v[24:27], v[176:179], v[40:43], v[24:27]
v_mfma_f32_16x16x32_bf16 v[28:31], v[240:243], v[40:43], v[28:31]
v_mfma_f32_16x16x32_bf16 v[32:35], v[176:179], v[44:47], v[32:35]
v_mfma_f32_16x16x32_bf16 v[36:39], v[240:243], v[44:47], v[36:39]
v_and_b32 v48, v101, v16
v_and_b32 v49, v101, v17
v_and_b32 v50, v101, v18
v_and_b32 v51, v101, v19
v_and_b32 v52, v117, v16
v_and_b32 v53, v117, v17
v_and_b32 v54, v117, v18
v_and_b32 v55, v117, v19
s_nop 0
v_mfma_f32_16x16x32_bf16 v[24:27], v[180:183], v[48:51], v[24:27]
v_mfma_f32_16x16x32_bf16 v[28:31], v[244:247], v[48:51], v[28:31]
v_mfma_f32_16x16x32_bf16 v[32:35], v[180:183], v[52:55], v[32:35]
v_mfma_f32_16x16x32_bf16 v[36:39], v[244:247], v[52:55], v[36:39]
v_and_b32 v40, v102, v16
v_and_b32 v41, v102, v17
v_and_b32 v42, v102, v18
v_and_b32 v43, v102, v19
v_and_b32 v44, v118, v16
v_and_b32 v45, v118, v17
v_and_b32 v46, v118, v18
v_and_b32 v47, v118, v19
s_nop 0
v_mfma_f32_16x16x32_bf16 v[24:27], v[184:187], v[40:43], v[24:27]
v_mfma_f32_16x16x32_bf16 v[28:31], v[248:251], v[40:43], v[28:31]
v_mfma_f32_16x16x32_bf16 v[32:35], v[184:187], v[44:47], v[32:35]
v_mfma_f32_16x16x32_bf16 v[36:39], v[248:251], v[44:47], v[36:39]
v_and_b32 v48, v103, v16
v_and_b32 v49, v103, v17
v_and_b32 v50, v103, v18
v_and_b32 v51, v103, v19
v_and_b32 v52, v119, v16
v_and_b32 v53, v119, v17
v_and_b32 v54, v119, v18
v_and_b32 v55, v119, v19
s_nop 0
v_mfma_f32_16x16x32_bf16 v[24:27], v[188:191], v[48:51], v[24:27]
v_mfma_f32_16x16x32_bf16 v[28:31], v[252:255], v[48:51], v[28:31]
v_mfma_f32_16x16x32_bf16 v[32:35], v[188:191], v[52:55], v[32:35]
v_mfma_f32_16x16x32_bf16 v[36:39], v[252:255], v[52:55], v[36:39]
s_nop 7
s_nop 1
v_add_f32_dpp v56, v24, v24 row_ror:8 row_mask:0xf bank_mask:0xf
v_add_f32_dpp v57, v25, v25 row_ror:8 row_mask:0xf bank_mask:0xf
v_add_f32_dpp v58, v26, v26 row_ror:8 row_mask:0xf bank_mask:0xf
v_add_f32_dpp v59, v27, v27 row_ror:8 row_mask:0xf bank_mask:0xf
v_add_f32_dpp v60, v28, v28 row_ror:8 row_mask:0xf bank_mask:0xf
v_add_f32_dpp v61, v29, v29 row_ror:8 row_mask:0xf bank_mask:0xf
v_add_f32_dpp v62, v30, v30 row_ror:8 row_mask:0xf bank_mask:0xf
v_add_f32_dpp v63, v31, v31 row_ror:8 row_mask:0xf bank_mask:0xf
v_add_f32_dpp v64, v32, v32 row_ror:8 row_mask:0xf bank_mask:0xf
v_add_f32_dpp v65, v33, v33 row_ror:8 row_mask:0xf bank_mask:0xf
v_add_f32_dpp v66, v34, v34 row_ror:8 row_mask:0xf bank_mask:0xf
v_add_f32_dpp v67, v35, v35 row_ror:8 row_mask:0xf bank_mask:0xf
v_add_f32_dpp v68, v36, v36 row_ror:8 row_mask:0xf bank_mask:0xf
v_add_f32_dpp v69, v37, v37 row_ror:8 row_mask:0xf bank_mask:0xf
v_add_f32_dpp v70, v38, v38 row_ror:8 row_mask:0xf bank_mask:0xf
v_add_f32_dpp v71, v39, v39 row_ror:8 row_mask:0xf bank_mask:0xf
ds_write_b32 v13, v56 offset:0
ds_write_b32 v13, v57 offset:32
ds_write_b32 v13, v58 offset:64
ds_write_b32 v13, v59 offset:96
ds_write_b32 v13, v60 offset:512
ds_write_b32 v13, v61 offset:544
ds_write_b32 v13, v62 offset:576
ds_write_b32 v13, v63 offset:608
ds_write_b32 v13, v64 offset:4224
ds_write_b32 v13, v65 offset:4256
ds_write_b32 v13, v66 offset:4288
ds_write_b32 v13, v67 offset:4320
ds_write_b32 v13, v68 offset:4736
ds_write_b32 v13, v69 offset:4768
ds_write_b32 v13, v70 offset:4800
ds_write_b32 v13, v71 offset:4832
s_mov_b64 exec, 1
ds_add_u32 v6, v7 offset:64
ds_add_u32 v6, v7 offset:68
s_mov_b64 exec, -1
s_mov_b32 s46, 0x40000
L_w23:
ds_read_b32 v8, v6 offset:8
s_waitcnt lgkmcnt(0)
v_readfirstlane_b32 s43, v8
s_nop 0
s_cmp_ge_u32 s43, 4
s_cbranch_scc1 L_wd24
s_sub_u32 s46, s46, 1
s_cbranch_scc1 L_wd24
s_sleep 16
s_branch L_w23
L_wd24:
s_mov_b32 s46, 0x40000
L_w25:
ds_read_b32 v8, v6 offset:12
s_waitcnt lgkmcnt(0)
v_readfirstlane_b32 s43, v8
s_nop 0
s_cmp_ge_u32 s43, 4
s_cbranch_scc1 L_wd26
s_sub_u32 s46, s46, 1
s_cbranch_scc1 L_wd26
s_sleep 16
s_branch L_w25
L_wd26:
v_mov_b32 v24, 0
v_mov_b32 v25, 0
v_mov_b32 v26, 0
v_mov_b32 v27, 0
ds_read_b128 v[56:59], v10 offset:0
ds_read_b128 v[60:63], v11 offset:8448
ds_read_b128 v[64:67], v10 offset:64
ds_read_b128 v[68:71], v11 offset:8512
ds_read_b128 v[72:75], v10 offset:128
ds_read_b128 v[76:79], v11 offset:8576
ds_read_b128 v[80:83], v10 offset:192
ds_read_b128 v[84:87], v11 offset:8640
s_waitcnt lgkmcnt(6)
v_mfma_f32_16x16x32_bf16 v[24:27], v[56:59], v[60:63], v[24:27]
s_waitcnt lgkmcnt(4)
v_mfma_f32_16x16x32_bf16 v[24:27], v[64:67], v[68:71], v[24:27]
s_waitcnt lgkmcnt(2)
v_mfma_f32_16x16x32_bf16 v[24:27], v[72:75], v[76:79], v[24:27]
s_waitcnt lgkmcnt(0)
v_mfma_f32_16x16x32_bf16 v[24:27], v[80:83], v[84:87], v[24:27]
ds_read_b128 v[56:59], v10 offset:256
ds_read_b128 v[60:63], v11 offset:8704
ds_read_b128 v[64:67], v10 offset:320
ds_read_b128 v[68:71], v11 offset:8768
ds_read_b128 v[72:75], v10 offset:384
ds_read_b128 v[76:79], v11 offset:8832
ds_read_b128 v[80:83], v10 offset:448
ds_read_b128 v[84:87], v11 offset:8896
s_waitcnt lgkmcnt(6)
v_mfma_f32_16x16x32_bf16 v[24:27], v[56:59], v[60:63], v[24:27]
s_waitcnt lgkmcnt(4)
v_mfma_f32_16x16x32_bf16 v[24:27], v[64:67], v[68:71], v[24:27]
s_waitcnt lgkmcnt(2)
v_mfma_f32_16x16x32_bf16 v[24:27], v[72:75], v[76:79], v[24:27]
s_waitcnt lgkmcnt(0)
v_mfma_f32_16x16x32_bf16 v[24:27], v[80:83], v[84:87], v[24:27]
ds_read_b128 v[56:59], v10 offset:512
ds_read_b128 v[60:63], v11 offset:8960
ds_read_b128 v[64:67], v10 offset:576
ds_read_b128 v[68:71], v11 offset:9024
ds_read_b128 v[72:75], v10 offset:640
ds_read_b128 v[76:79], v11 offset:9088
ds_read_b128 v[80:83], v10 offset:704
ds_read_b128 v[84:87], v11 offset:9152
s_waitcnt lgkmcnt(6)
v_mfma_f32_16x16x32_bf16 v[24:27], v[56:59], v[60:63], v[24:27]
s_waitcnt lgkmcnt(4)
v_mfma_f32_16x16x32_bf16 v[24:27], v[64:67], v[68:71], v[24:27]
s_waitcnt lgkmcnt(2)
v_mfma_f32_16x16x32_bf16 v[24:27], v[72:75], v[76:79], v[24:27]
s_waitcnt lgkmcnt(0)
v_mfma_f32_16x16x32_bf16 v[24:27], v[80:83], v[84:87], v[24:27]
ds_read_b128 v[56:59], v10 offset:768
ds_read_b128 v[60:63], v11 offset:9216
ds_read_b128 v[64:67], v10 offset:832
ds_read_b128 v[68:71], v11 offset:9280
ds_read_b128 v[72:75], v10 offset:896
ds_read_b128 v[76:79], v11 offset:9344
ds_read_b128 v[80:83], v10 offset:960
ds_read_b128 v[84:87], v11 offset:9408
s_waitcnt lgkmcnt(6)
v_mfma_f32_16x16x32_bf16 v[24:27], v[56:59], v[60:63], v[24:27]
s_waitcnt lgkmcnt(4)
v_mfma_f32_16x16x32_bf16 v[24:27], v[64:67], v[68:71], v[24:27]
s_waitcnt lgkmcnt(2)
v_mfma_f32_16x16x32_bf16 v[24:27], v[72:75], v[76:79], v[24:27]
s_waitcnt lgkmcnt(0)
v_mfma_f32_16x16x32_bf16 v[24:27], v[80:83], v[84:87], v[24:27]
ds_read_b128 v[56:59], v10 offset:1024
ds_read_b128 v[60:63], v11 offset:9472
ds_read_b128 v[64:67], v10 offset:1088
ds_read_b128 v[68:71], v11 offset:9536
ds_read_b128 v[72:75], v10 offset:1152
ds_read_b128 v[76:79], v11 offset:9600
ds_read_b128 v[80:83], v10 offset:1216
ds_read_b128 v[84:87], v11 offset:9664
s_waitcnt lgkmcnt(6)
v_mfma_f32_16x16x32_bf16 v[24:27], v[56:59], v[60:63], v[24:27]
s_waitcnt lgkmcnt(4)
v_mfma_f32_16x16x32_bf16 v[24:27], v[64:67], v[68:71], v[24:27]
s_waitcnt lgkmcnt(2)
v_mfma_f32_16x16x32_bf16 v[24:27], v[72:75], v[76:79], v[24:27]
s_waitcnt lgkmcnt(0)
v_mfma_f32_16x16x32_bf16 v[24:27], v[80:83], v[84:87], v[24:27]
ds_read_b128 v[56:59], v10 offset:1280
ds_read_b128 v[60:63], v11 offset:9728
ds_read_b128 v[64:67], v10 offset:1344
ds_read_b128 v[68:71], v11 offset:9792
ds_read_b128 v[72:75], v10 offset:1408
ds_read_b128 v[76:79], v11 offset:9856
ds_read_b128 v[80:83], v10 offset:1472
ds_read_b128 v[84:87], v11 offset:9920
s_waitcnt lgkmcnt(6)
v_mfma_f32_16x16x32_bf16 v[24:27], v[56:59], v[60:63], v[24:27]
s_waitcnt lgkmcnt(4)
v_mfma_f32_16x16x32_bf16 v[24:27], v[64:67], v[68:71], v[24:27]
s_waitcnt lgkmcnt(2)
v_mfma_f32_16x16x32_bf16 v[24:27], v[72:75], v[76:79], v[24:27]
s_waitcnt lgkmcnt(0)
v_mfma_f32_16x16x32_bf16 v[24:27], v[80:83], v[84:87], v[24:27]
ds_read_b128 v[56:59], v10 offset:1536
ds_read_b128 v[60:63], v11 offset:9984
ds_read_b128 v[64:67], v10 offset:1600
ds_read_b128 v[68:71], v11 offset:10048
ds_read_b128 v[72:75], v10 offset:1664
ds_read_b128 v[76:79], v11 offset:10112
ds_read_b128 v[80:83], v10 offset:1728
ds_read_b128 v[84:87], v11 offset:10176
s_waitcnt lgkmcnt(6)
v_mfma_f32_16x16x32_bf16 v[24:27], v[56:59], v[60:63], v[24:27]
s_waitcnt lgkmcnt(4)
v_mfma_f32_16x16x32_bf16 v[24:27], v[64:67], v[68:71], v[24:27]
s_waitcnt lgkmcnt(2)
v_mfma_f32_16x16x32_bf16 v[24:27], v[72:75], v[76:79], v[24:27]
s_waitcnt lgkmcnt(0)
v_mfma_f32_16x16x32_bf16 v[24:27], v[80:83], v[84:87], v[24:27]
ds_read_b128 v[56:59], v10 offset:1792
ds_read_b128 v[60:63], v11 offset:10240
ds_read_b128 v[64:67], v10 offset:1856
ds_read_b128 v[68:71], v11 offset:10304
ds_read_b128 v[72:75], v10 offset:1920
ds_read_b128 v[76:79], v11 offset:10368
ds_read_b128 v[80:83], v10 offset:1984
ds_read_b128 v[84:87], v11 offset:10432
s_waitcnt lgkmcnt(6)
v_mfma_f32_16x16x32_bf16 v[24:27], v[56:59], v[60:63], v[24:27]
s_waitcnt lgkmcnt(4)
v_mfma_f32_16x16x32_bf16 v[24:27], v[64:67], v[68:71], v[24:27]
s_waitcnt lgkmcnt(2)
v_mfma_f32_16x16x32_bf16 v[24:27], v[72:75], v[76:79], v[24:27]
s_waitcnt lgkmcnt(0)
v_mfma_f32_16x16x32_bf16 v[24:27], v[80:83], v[84:87], v[24:27]
s_lshl_b32 s36, s22, 6
v_bfe_u32 v9, v0, 1, 1
v_lshlrev_b32 v8, 4, v4
v_lshl_add_u32 v8, v9, 8, v8
v_add_u32 v8, s36, v8
v_add_u32 v8, 157696, v8
s_nop 4
v_add_f32_dpp v28, v24, v24 quad_perm:[1,0,3,2] row_mask:0xf bank_mask:0xf
v_add_f32_dpp v29, v25, v25 quad_perm:[1,0,3,2] row_mask:0xf bank_mask:0xf
v_add_f32_dpp v30, v26, v26 quad_perm:[1,0,3,2] row_mask:0xf bank_mask:0xf
v_add_f32_dpp v31, v27, v27 quad_perm:[1,0,3,2] row_mask:0xf bank_mask:0xf
ds_write_b128 v8, v[28:31]
s_mov_b64 exec, 1
ds_add_rtn_u32 v8, v6, v7 offset:36
s_mov_b64 exec, -1
s_waitcnt lgkmcnt(0)
v_readfirstlane_b32 s43, v8
s_nop 0
s_cmp_lg_u32 s43, 3
s_cbranch_scc1 L_nopub27
v_add_u32 v9, 157696, v2
s_mov_b32 exec_hi, 0
ds_read_b128 v[56:59], v9
s_add_u32 s37, s61, 1048576
s_waitcnt lgkmcnt(0)
v_and_or_b32 v56, v56, s57, v20
v_and_or_b32 v57, v57, s57, v21
v_and_or_b32 v58, v58, s57, v22
v_and_or_b32 v59, v59, s57, v23
buffer_store_dwordx4 v[56:59], v120, s[32:35], s37 offen sc1
s_mov_b64 exec, -1
s_nop 1
L_nopub27:
s_cmp_lg_u32 s22, 0
s_cbranch_scc1 L_nop28
s_add_u32 s39, s47, 1576960
s_add_u32 s43, s21, 8
s_and_b32 s43, s43, 15
s_cmp_lg_u32 s43, s20
s_cbranch_scc1 L_oth29
s_mov_b32 s46, 0x40000
L_w31:
ds_read_b32 v8, v6 offset:80
s_waitcnt lgkmcnt(0)
v_readfirstlane_b32 s43, v8
s_nop 0
s_cmp_ge_u32 s43, 36
s_cbranch_scc1 L_wd32
s_sub_u32 s46, s46, 1
s_cbranch_scc1 L_wd32
s_sleep 16
s_branch L_w31
L_wd32:
s_add_u32 s37, s60, 1048576
v_lshrrev_b32 v3, 5, v0
v_lshl_add_u32 v3, v3, 8, v121
s_mov_b32 s46, 32768
L_gp33:
buffer_load_dwordx4 v[56:59], v3, s[32:35], s37 offen offset:0 sc1
buffer_load_dwordx4 v[60:63], v3, s[32:35], s37 offen offset:512 sc1
buffer_load_dwordx4 v[64:67], v3, s[32:35], s37 offen offset:1024 sc1
buffer_load_dwordx4 v[68:71], v3, s[32:35], s37 offen offset:1536 sc1
buffer_load_dwordx4 v[72:75], v3, s[32:35], s37 offen offset:2048 sc1
buffer_load_dwordx4 v[76:79], v3, s[32:35], s37 offen offset:2560 sc1
buffer_load_dwordx4 v[80:83], v3, s[32:35], s37 offen offset:3072 sc1
buffer_load_dwordx4 v[84:87], v3, s[32:35], s37 offen offset:3584 sc1
s_mov_b64 s[62:63], 0
s_waitcnt vmcnt(7)
v_perm_b32 v8, v57, v56, s58
v_perm_b32 v9, v59, v58, s59
v_or_b32 v8, v8, v9
v_cmp_ne_u32 vcc, s56, v8
s_or_b64 s[62:63], s[62:63], vcc
s_waitcnt vmcnt(6)
v_perm_b32 v8, v61, v60, s58
v_perm_b32 v9, v63, v62, s59
v_or_b32 v8, v8, v9
v_cmp_ne_u32 vcc, s56, v8
s_or_b64 s[62:63], s[62:63], vcc
s_waitcnt vmcnt(5)
v_perm_b32 v8, v65, v64, s58
v_perm_b32 v9, v67, v66, s59
v_or_b32 v8, v8, v9
v_cmp_ne_u32 vcc, s56, v8
s_or_b64 s[62:63], s[62:63], vcc
s_waitcnt vmcnt(4)
v_perm_b32 v8, v69, v68, s58
v_perm_b32 v9, v71, v70, s59
v_or_b32 v8, v8, v9
v_cmp_ne_u32 vcc, s56, v8
s_or_b64 s[62:63], s[62:63], vcc
s_waitcnt vmcnt(3)
v_perm_b32 v8, v73, v72, s58
v_perm_b32 v9, v75, v74, s59
v_or_b32 v8, v8, v9
v_cmp_ne_u32 vcc, s56, v8
s_or_b64 s[62:63], s[62:63], vcc
s_waitcnt vmcnt(2)
v_perm_b32 v8, v77, v76, s58
v_perm_b32 v9, v79, v78, s59
v_or_b32 v8, v8, v9
v_cmp_ne_u32 vcc, s56, v8
s_or_b64 s[62:63], s[62:63], vcc
s_waitcnt vmcnt(1)
v_perm_b32 v8, v81, v80, s58
v_perm_b32 v9, v83, v82, s59
v_or_b32 v8, v8, v9
v_cmp_ne_u32 vcc, s56, v8
s_or_b64 s[62:63], s[62:63], vcc
s_waitcnt vmcnt(0)
v_perm_b32 v8, v85, v84, s58
v_perm_b32 v9, v87, v86, s59
v_or_b32 v8, v8, v9
v_cmp_ne_u32 vcc, s56, v8
s_or_b64 s[62:63], s[62:63], vcc
s_cmp_eq_u64 s[62:63], 0
s_cbranch_scc1 L_gpd34
s_sub_u32 s46, s46, 1
s_cbranch_scc1 L_gpd34
s_sleep 8
s_branch L_gp33
L_gpd34:
v_and_b32 v56, s57, v56
v_and_b32 v57, s57, v57
v_and_b32 v58, s57, v58
v_and_b32 v59, s57, v59
v_and_b32 v60, s57, v60
v_and_b32 v61, s57, v61
v_and_b32 v62, s57, v62
v_and_b32 v63, s57, v63
v_and_b32 v64, s57, v64
v_and_b32 v65, s57, v65
v_and_b32 v66, s57, v66
v_and_b32 v67, s57, v67
v_and_b32 v68, s57, v68
v_and_b32 v69, s57, v69
v_and_b32 v70, s57, v70
v_and_b32 v71, s57, v71
v_and_b32 v72, s57, v72
v_and_b32 v73, s57, v73
v_and_b32 v74, s57, v74
v_and_b32 v75, s57, v75
v_and_b32 v76, s57, v76
v_and_b32 v77, s57, v77
v_and_b32 v78, s57, v78
v_and_b32 v79, s57, v79
v_and_b32 v80, s57, v80
v_and_b32 v81, s57, v81
v_and_b32 v82, s57, v82
v_and_b32 v83, s57, v83
v_and_b32 v84, s57, v84
v_and_b32 v85, s57, v85
v_and_b32 v86, s57, v86
v_and_b32 v87, s57, v87
v_add_f32 v56, v56, v72
v_add_f32 v57, v57, v73
v_add_f32 v58, v58, v74
v_add_f32 v59, v59, v75
v_add_f32 v60, v60, v76
v_add_f32 v61, v61, v77
v_add_f32 v62, v62, v78
v_add_f32 v63, v63, v79
v_add_f32 v64, v64, v80
v_add_f32 v65, v65, v81
v_add_f32 v66, v66, v82
v_add_f32 v67, v67, v83
v_add_f32 v68, v68, v84
v_add_f32 v69, v69, v85
v_add_f32 v70, v70, v86
v_add_f32 v71, v71, v87
v_add_f32 v56, v56, v64
v_add_f32 v57, v57, v65
v_add_f32 v58, v58, v66
v_add_f32 v59, v59, v67
v_add_f32 v60, v60, v68
v_add_f32 v61, v61, v69
v_add_f32 v62, v62, v70
v_add_f32 v63, v63, v71
v_add_f32 v56, v56, v60
v_add_f32 v57, v57, v61
v_add_f32 v58, v58, v62
v_add_f32 v59, v59, v63
v_mov_b32 v60, v56
v_mov_b32 v61, v57
v_mov_b32 v62, v58
v_mov_b32 v63, v59
s_nop 1
v_permlane32_swap_b32 v56, v60
v_permlane32_swap_b32 v57, v61
v_permlane32_swap_b32 v58, v62
v_permlane32_swap_b32 v59, v63
v_add_f32 v56, v56, v60
v_add_f32 v57, v57, v61
v_add_f32 v58, v58, v62
v_add_f32 v59, v59, v63
v_max_f32 v60, v56, v57
v_max3_f32 v60, v60, v58, v59
s_nop 1
v_max_f32_dpp v60, v60, v60 row_ror:8 row_mask:0xf bank_mask:0xf
s_nop 1
v_max_f32_dpp v60, v60, v60 row_ror:4 row_mask:0xf bank_mask:0xf
s_nop 1
v_max_f32_dpp v60, v60, v60 row_ror:2 row_mask:0xf bank_mask:0xf
s_nop 1
v_max_f32_dpp v60, v60, v60 row_ror:1 row_mask:0xf bank_mask:0xf
s_mov_b32 s36, 0x3e0293ee
v_sub_f32 v56, v56, v60
v_mul_f32 v56, s36, v56
v_exp_f32 v56, v56
v_sub_f32 v57, v57, v60
v_mul_f32 v57, s36, v57
v_exp_f32 v57, v57
v_sub_f32 v58, v58, v60
v_mul_f32 v58, s36, v58
v_exp_f32 v58, v58
v_sub_f32 v59, v59, v60
v_mul_f32 v59, s36, v59
v_exp_f32 v59, v59
s_nop 0
v_add_f32 v60, v56, v57
v_add_f32 v61, v58, v59
v_add_f32 v60, v60, v61
s_nop 1
v_add_f32_dpp v60, v60, v60 row_ror:8 row_mask:0xf bank_mask:0xf
s_nop 1
v_add_f32_dpp v60, v60, v60 row_ror:4 row_mask:0xf bank_mask:0xf
s_nop 1
v_add_f32_dpp v60, v60, v60 row_ror:2 row_mask:0xf bank_mask:0xf
s_nop 1
v_add_f32_dpp v60, v60, v60 row_ror:1 row_mask:0xf bank_mask:0xf
v_rcp_f32 v60, v60
s_nop 0
v_mul_f32 v56, v56, v60
v_mul_f32 v57, v57, v60
v_mul_f32 v58, v58, v60
v_mul_f32 v59, v59, v60
v_and_or_b32 v56, v56, s57, v20
v_and_or_b32 v57, v57, s57, v21
v_and_or_b32 v58, v58, s57, v22
v_and_or_b32 v59, v59, s57, v23
s_mov_b32 exec_hi, 0
buffer_store_dwordx4 v[56:59], v120, s[32:35], s39 offen sc1
s_mov_b64 exec, -1
s_branch L_com30
L_oth29:
s_mov_b32 s46, 0x40000
L_w35:
ds_read_b32 v8, v6 offset:80
s_waitcnt lgkmcnt(0)
v_readfirstlane_b32 s43, v8
s_nop 0
s_cmp_ge_u32 s43, 40
s_cbranch_scc1 L_wd36
s_sub_u32 s46, s46, 1
s_cbranch_scc1 L_wd36
s_sleep 16
s_branch L_w35
L_wd36:
s_mov_b32 s46, 32768
L_pp37:
buffer_load_dwordx4 v[56:59], v121, s[32:35], s39 offen sc1
s_waitcnt vmcnt(0)
v_perm_b32 v8, v57, v56, s58
v_perm_b32 v9, v59, v58, s59
v_or_b32 v8, v8, v9
v_cmp_ne_u32 vcc, s56, v8
s_cmp_eq_u64 vcc, 0
s_cbranch_scc1 L_com30
s_sub_u32 s46, s46, 1
s_cbranch_scc1 L_com30
s_sleep 8
s_branch L_pp37
L_com30:
v_lshrrev_b32 v8, 5, v0
v_sub_u32 v9, 0, v8
v_and_b32 v9, 0xffff0000, v9
v_mov_b32 v14, 0x03020302
v_and_b32 v60, s57, v56
v_and_b32 v64, v60, v9
v_sub_f32 v60, v60, v64
v_perm_b32 v60, v60, v60, v14
v_and_b32 v61, s57, v57
v_and_b32 v64, v61, v9
v_sub_f32 v61, v61, v64
v_perm_b32 v61, v61, v61, v14
v_and_b32 v62, s57, v58
v_and_b32 v64, v62, v9
v_sub_f32 v62, v62, v64
v_perm_b32 v62, v62, v62, v14
v_and_b32 v63, s57, v59
v_and_b32 v64, v63, v9
v_sub_f32 v63, v63, v64
v_perm_b32 v63, v63, v63, v14
v_lshlrev_b32 v8, 8, v8
v_lshl_add_u32 v8, v5, 2, v8
v_and_b32 v9, 1, v4
v_lshl_add_u32 v8, v9, 9, v8
v_add_u32 v8, 159232, v8
ds_write_b32 v8, v60 offset:0
ds_write_b32 v8, v61 offset:64
ds_write_b32 v8, v62 offset:128
ds_write_b32 v8, v63 offset:192
s_mov_b64 exec, 1
ds_add_u32 v6, v7 offset:52
s_mov_b64 exec, -1
L_nop28:
s_mov_b32 s46, 0x40000
L_w38:
ds_read_b32 v8, v6 offset:52
s_waitcnt lgkmcnt(0)
v_readfirstlane_b32 s43, v8
s_nop 0
s_cmp_ge_u32 s43, 1
s_cbranch_scc1 L_wd39
s_sub_u32 s46, s46, 1
s_cbranch_scc1 L_wd39
s_sleep 16
s_branch L_w38
L_wd39:
ds_read_b128 v[88:91], v12 offset:1024
ds_read_b128 v[92:95], v12 offset:1040
ds_read_b128 v[96:99], v12 offset:1056
ds_read_b128 v[100:103], v12 offset:1072
ds_read_b128 v[104:107], v12 offset:1536
ds_read_b128 v[108:111], v12 offset:1552
ds_read_b128 v[112:115], v12 offset:1568
ds_read_b128 v[116:119], v12 offset:1584
v_mov_b32 v24, 0
v_mov_b32 v25, 0
v_mov_b32 v26, 0
v_mov_b32 v27, 0
v_mov_b32 v28, 0
v_mov_b32 v29, 0
v_mov_b32 v30, 0
v_mov_b32 v31, 0
v_mov_b32 v32, 0
v_mov_b32 v33, 0
v_mov_b32 v34, 0
v_mov_b32 v35, 0
v_mov_b32 v36, 0
v_mov_b32 v37, 0
v_mov_b32 v38, 0
v_mov_b32 v39, 0
s_waitcnt vmcnt(0) lgkmcnt(0)
v_and_b32 v40, v88, v16
v_and_b32 v41, v88, v17
v_and_b32 v42, v88, v18
v_and_b32 v43, v88, v19
v_and_b32 v44, v104, v16
v_and_b32 v45, v104, v17
v_and_b32 v46, v104, v18
v_and_b32 v47, v104, v19
s_nop 0
v_mfma_f32_16x16x32_bf16 v[24:27], v[128:131], v[40:43], v[24:27]
v_mfma_f32_16x16x32_bf16 v[28:31], v[192:195], v[40:43], v[28:31]
v_mfma_f32_16x16x32_bf16 v[32:35], v[128:131], v[44:47], v[32:35]
v_mfma_f32_16x16x32_bf16 v[36:39], v[192:195], v[44:47], v[36:39]
v_and_b32 v48, v89, v16
v_and_b32 v49, v89, v17
v_and_b32 v50, v89, v18
v_and_b32 v51, v89, v19
v_and_b32 v52, v105, v16
v_and_b32 v53, v105, v17
v_and_b32 v54, v105, v18
v_and_b32 v55, v105, v19
s_nop 0
v_mfma_f32_16x16x32_bf16 v[24:27], v[132:135], v[48:51], v[24:27]
v_mfma_f32_16x16x32_bf16 v[28:31], v[196:199], v[48:51], v[28:31]
v_mfma_f32_16x16x32_bf16 v[32:35], v[132:135], v[52:55], v[32:35]
v_mfma_f32_16x16x32_bf16 v[36:39], v[196:199], v[52:55], v[36:39]
v_and_b32 v40, v90, v16
v_and_b32 v41, v90, v17
v_and_b32 v42, v90, v18
v_and_b32 v43, v90, v19
v_and_b32 v44, v106, v16
v_and_b32 v45, v106, v17
v_and_b32 v46, v106, v18
v_and_b32 v47, v106, v19
s_nop 0
v_mfma_f32_16x16x32_bf16 v[24:27], v[136:139], v[40:43], v[24:27]
v_mfma_f32_16x16x32_bf16 v[28:31], v[200:203], v[40:43], v[28:31]
v_mfma_f32_16x16x32_bf16 v[32:35], v[136:139], v[44:47], v[32:35]
v_mfma_f32_16x16x32_bf16 v[36:39], v[200:203], v[44:47], v[36:39]
v_and_b32 v48, v91, v16
v_and_b32 v49, v91, v17
v_and_b32 v50, v91, v18
v_and_b32 v51, v91, v19
v_and_b32 v52, v107, v16
v_and_b32 v53, v107, v17
v_and_b32 v54, v107, v18
v_and_b32 v55, v107, v19
s_nop 0
v_mfma_f32_16x16x32_bf16 v[24:27], v[140:143], v[48:51], v[24:27]
v_mfma_f32_16x16x32_bf16 v[28:31], v[204:207], v[48:51], v[28:31]
v_mfma_f32_16x16x32_bf16 v[32:35], v[140:143], v[52:55], v[32:35]
v_mfma_f32_16x16x32_bf16 v[36:39], v[204:207], v[52:55], v[36:39]
v_and_b32 v40, v92, v16
v_and_b32 v41, v92, v17
v_and_b32 v42, v92, v18
v_and_b32 v43, v92, v19
v_and_b32 v44, v108, v16
v_and_b32 v45, v108, v17
v_and_b32 v46, v108, v18
v_and_b32 v47, v108, v19
s_nop 0
v_mfma_f32_16x16x32_bf16 v[24:27], v[144:147], v[40:43], v[24:27]
v_mfma_f32_16x16x32_bf16 v[28:31], v[208:211], v[40:43], v[28:31]
v_mfma_f32_16x16x32_bf16 v[32:35], v[144:147], v[44:47], v[32:35]
v_mfma_f32_16x16x32_bf16 v[36:39], v[208:211], v[44:47], v[36:39]
v_and_b32 v48, v93, v16
v_and_b32 v49, v93, v17
v_and_b32 v50, v93, v18
v_and_b32 v51, v93, v19
v_and_b32 v52, v109, v16
v_and_b32 v53, v109, v17
v_and_b32 v54, v109, v18
v_and_b32 v55, v109, v19
s_nop 0
v_mfma_f32_16x16x32_bf16 v[24:27], v[148:151], v[48:51], v[24:27]
v_mfma_f32_16x16x32_bf16 v[28:31], v[212:215], v[48:51], v[28:31]
v_mfma_f32_16x16x32_bf16 v[32:35], v[148:151], v[52:55], v[32:35]
v_mfma_f32_16x16x32_bf16 v[36:39], v[212:215], v[52:55], v[36:39]
v_and_b32 v40, v94, v16
v_and_b32 v41, v94, v17
v_and_b32 v42, v94, v18
v_and_b32 v43, v94, v19
v_and_b32 v44, v110, v16
v_and_b32 v45, v110, v17
v_and_b32 v46, v110, v18
v_and_b32 v47, v110, v19
s_nop 0
v_mfma_f32_16x16x32_bf16 v[24:27], v[152:155], v[40:43], v[24:27]
v_mfma_f32_16x16x32_bf16 v[28:31], v[216:219], v[40:43], v[28:31]
v_mfma_f32_16x16x32_bf16 v[32:35], v[152:155], v[44:47], v[32:35]
v_mfma_f32_16x16x32_bf16 v[36:39], v[216:219], v[44:47], v[36:39]
v_and_b32 v48, v95, v16
v_and_b32 v49, v95, v17
v_and_b32 v50, v95, v18
v_and_b32 v51, v95, v19
v_and_b32 v52, v111, v16
v_and_b32 v53, v111, v17
v_and_b32 v54, v111, v18
v_and_b32 v55, v111, v19
s_nop 0
v_mfma_f32_16x16x32_bf16 v[24:27], v[156:159], v[48:51], v[24:27]
v_mfma_f32_16x16x32_bf16 v[28:31], v[220:223], v[48:51], v[28:31]
v_mfma_f32_16x16x32_bf16 v[32:35], v[156:159], v[52:55], v[32:35]
v_mfma_f32_16x16x32_bf16 v[36:39], v[220:223], v[52:55], v[36:39]
v_and_b32 v40, v96, v16
v_and_b32 v41, v96, v17
v_and_b32 v42, v96, v18
v_and_b32 v43, v96, v19
v_and_b32 v44, v112, v16
v_and_b32 v45, v112, v17
v_and_b32 v46, v112, v18
v_and_b32 v47, v112, v19
s_nop 0
v_mfma_f32_16x16x32_bf16 v[24:27], v[160:163], v[40:43], v[24:27]
v_mfma_f32_16x16x32_bf16 v[28:31], v[224:227], v[40:43], v[28:31]
v_mfma_f32_16x16x32_bf16 v[32:35], v[160:163], v[44:47], v[32:35]
v_mfma_f32_16x16x32_bf16 v[36:39], v[224:227], v[44:47], v[36:39]
v_and_b32 v48, v97, v16
v_and_b32 v49, v97, v17
v_and_b32 v50, v97, v18
v_and_b32 v51, v97, v19
v_and_b32 v52, v113, v16
v_and_b32 v53, v113, v17
v_and_b32 v54, v113, v18
v_and_b32 v55, v113, v19
s_nop 0
v_mfma_f32_16x16x32_bf16 v[24:27], v[164:167], v[48:51], v[24:27]
v_mfma_f32_16x16x32_bf16 v[28:31], v[228:231], v[48:51], v[28:31]
v_mfma_f32_16x16x32_bf16 v[32:35], v[164:167], v[52:55], v[32:35]
v_mfma_f32_16x16x32_bf16 v[36:39], v[228:231], v[52:55], v[36:39]
v_and_b32 v40, v98, v16
v_and_b32 v41, v98, v17
v_and_b32 v42, v98, v18
v_and_b32 v43, v98, v19
v_and_b32 v44, v114, v16
v_and_b32 v45, v114, v17
v_and_b32 v46, v114, v18
v_and_b32 v47, v114, v19
s_nop 0
v_mfma_f32_16x16x32_bf16 v[24:27], v[168:171], v[40:43], v[24:27]
v_mfma_f32_16x16x32_bf16 v[28:31], v[232:235], v[40:43], v[28:31]
v_mfma_f32_16x16x32_bf16 v[32:35], v[168:171], v[44:47], v[32:35]
v_mfma_f32_16x16x32_bf16 v[36:39], v[232:235], v[44:47], v[36:39]
v_and_b32 v48, v99, v16
v_and_b32 v49, v99, v17
v_and_b32 v50, v99, v18
v_and_b32 v51, v99, v19
v_and_b32 v52, v115, v16
v_and_b32 v53, v115, v17
v_and_b32 v54, v115, v18
v_and_b32 v55, v115, v19
s_nop 0
v_mfma_f32_16x16x32_bf16 v[24:27], v[172:175], v[48:51], v[24:27]
v_mfma_f32_16x16x32_bf16 v[28:31], v[236:239], v[48:51], v[28:31]
v_mfma_f32_16x16x32_bf16 v[32:35], v[172:175], v[52:55], v[32:35]
v_mfma_f32_16x16x32_bf16 v[36:39], v[236:239], v[52:55], v[36:39]
v_and_b32 v40, v100, v16
v_and_b32 v41, v100, v17
v_and_b32 v42, v100, v18
v_and_b32 v43, v100, v19
v_and_b32 v44, v116, v16
v_and_b32 v45, v116, v17
v_and_b32 v46, v116, v18
v_and_b32 v47, v116, v19
s_nop 0
v_mfma_f32_16x16x32_bf16 v[24:27], v[176:179], v[40:43], v[24:27]
v_mfma_f32_16x16x32_bf16 v[28:31], v[240:243], v[40:43], v[28:31]
v_mfma_f32_16x16x32_bf16 v[32:35], v[176:179], v[44:47], v[32:35]
v_mfma_f32_16x16x32_bf16 v[36:39], v[240:243], v[44:47], v[36:39]
v_and_b32 v48, v101, v16
v_and_b32 v49, v101, v17
v_and_b32 v50, v101, v18
v_and_b32 v51, v101, v19
v_and_b32 v52, v117, v16
v_and_b32 v53, v117, v17
v_and_b32 v54, v117, v18
v_and_b32 v55, v117, v19
s_nop 0
v_mfma_f32_16x16x32_bf16 v[24:27], v[180:183], v[48:51], v[24:27]
v_mfma_f32_16x16x32_bf16 v[28:31], v[244:247], v[48:51], v[28:31]
v_mfma_f32_16x16x32_bf16 v[32:35], v[180:183], v[52:55], v[32:35]
v_mfma_f32_16x16x32_bf16 v[36:39], v[244:247], v[52:55], v[36:39]
v_and_b32 v40, v102, v16
v_and_b32 v41, v102, v17
v_and_b32 v42, v102, v18
v_and_b32 v43, v102, v19
v_and_b32 v44, v118, v16
v_and_b32 v45, v118, v17
v_and_b32 v46, v118, v18
v_and_b32 v47, v118, v19
s_nop 0
v_mfma_f32_16x16x32_bf16 v[24:27], v[184:187], v[40:43], v[24:27]
v_mfma_f32_16x16x32_bf16 v[28:31], v[248:251], v[40:43], v[28:31]
v_mfma_f32_16x16x32_bf16 v[32:35], v[184:187], v[44:47], v[32:35]
v_mfma_f32_16x16x32_bf16 v[36:39], v[248:251], v[44:47], v[36:39]
v_and_b32 v48, v103, v16
v_and_b32 v49, v103, v17
v_and_b32 v50, v103, v18
v_and_b32 v51, v103, v19
v_and_b32 v52, v119, v16
v_and_b32 v53, v119, v17
v_and_b32 v54, v119, v18
v_and_b32 v55, v119, v19
s_nop 0
v_mfma_f32_16x16x32_bf16 v[24:27], v[188:191], v[48:51], v[24:27]
v_mfma_f32_16x16x32_bf16 v[28:31], v[252:255], v[48:51], v[28:31]
v_mfma_f32_16x16x32_bf16 v[32:35], v[188:191], v[52:55], v[32:35]
v_mfma_f32_16x16x32_bf16 v[36:39], v[252:255], v[52:55], v[36:39]
s_nop 7
s_nop 1
v_add_f32_dpp v56, v24, v24 row_ror:8 row_mask:0xf bank_mask:0xf
v_add_f32_dpp v57, v25, v25 row_ror:8 row_mask:0xf bank_mask:0xf
v_add_f32_dpp v58, v26, v26 row_ror:8 row_mask:0xf bank_mask:0xf
v_add_f32_dpp v59, v27, v27 row_ror:8 row_mask:0xf bank_mask:0xf
v_add_f32_dpp v60, v28, v28 row_ror:8 row_mask:0xf bank_mask:0xf
v_add_f32_dpp v61, v29, v29 row_ror:8 row_mask:0xf bank_mask:0xf
v_add_f32_dpp v62, v30, v30 row_ror:8 row_mask:0xf bank_mask:0xf
v_add_f32_dpp v63, v31, v31 row_ror:8 row_mask:0xf bank_mask:0xf
v_add_f32_dpp v64, v32, v32 row_ror:8 row_mask:0xf bank_mask:0xf
v_add_f32_dpp v65, v33, v33 row_ror:8 row_mask:0xf bank_mask:0xf
v_add_f32_dpp v66, v34, v34 row_ror:8 row_mask:0xf bank_mask:0xf
v_add_f32_dpp v67, v35, v35 row_ror:8 row_mask:0xf bank_mask:0xf
v_add_f32_dpp v68, v36, v36 row_ror:8 row_mask:0xf bank_mask:0xf
v_add_f32_dpp v69, v37, v37 row_ror:8 row_mask:0xf bank_mask:0xf
v_add_f32_dpp v70, v38, v38 row_ror:8 row_mask:0xf bank_mask:0xf
v_add_f32_dpp v71, v39, v39 row_ror:8 row_mask:0xf bank_mask:0xf
ds_write_b32 v13, v56 offset:8448
ds_write_b32 v13, v57 offset:8480
ds_write_b32 v13, v58 offset:8512
ds_write_b32 v13, v59 offset:8544
ds_write_b32 v13, v60 offset:8960
ds_write_b32 v13, v61 offset:8992
ds_write_b32 v13, v62 offset:9024
ds_write_b32 v13, v63 offset:9056
ds_write_b32 v13, v64 offset:12672
ds_write_b32 v13, v65 offset:12704
ds_write_b32 v13, v66 offset:12736
ds_write_b32 v13, v67 offset:12768
ds_write_b32 v13, v68 offset:13184
ds_write_b32 v13, v69 offset:13216
ds_write_b32 v13, v70 offset:13248
ds_write_b32 v13, v71 offset:13280
s_mov_b64 exec, 1
ds_add_u32 v6, v7 offset:72
ds_add_u32 v6, v7 offset:76
s_mov_b64 exec, -1
s_cmp_lg_u32 s22, 3
s_cbranch_scc1 L_now40
s_mov_b32 s46, 0x40000
L_w41:
ds_read_b32 v8, v6 offset:24
s_waitcnt lgkmcnt(0)
v_readfirstlane_b32 s43, v8
s_nop 0
s_cmp_ge_u32 s43, 4
s_cbranch_scc1 L_wd42
s_sub_u32 s46, s46, 1
s_cbranch_scc1 L_wd42
s_sleep 16
s_branch L_w41
L_wd42:
s_mov_b32 s46, 0x40000
L_w43:
ds_read_b32 v8, v6 offset:76
s_waitcnt lgkmcnt(0)
v_readfirstlane_b32 s43, v8
s_nop 0
s_cmp_ge_u32 s43, 4
s_cbranch_scc1 L_wd44
s_sub_u32 s46, s46, 1
s_cbranch_scc1 L_wd44
s_sleep 16
s_branch L_w43
L_wd44:
v_lshrrev_b32 v8, 5, v0
v_lshlrev_b32 v8, 9, v8
v_bfe_u32 v9, v0, 0, 1
v_lshl_add_u32 v8, v9, 7, v8
v_bfe_u32 v9, v0, 1, 1
v_lshl_add_u32 v8, v9, 6, v8
v_bfe_u32 v9, v0, 2, 1
v_lshl_add_u32 v8, v9, 8, v8
v_bfe_u32 v9, v0, 3, 1
v_lshl_add_u32 v8, v9, 5, v8
v_bfe_u32 v9, v0, 4, 1
v_lshl_add_u32 v8, v9, 4, v8
v_add_u32 v8, 147328, v8
ds_read_b128 v[24:27], v8 offset:0
ds_read_b128 v[28:31], v8 offset:1024
s_add_u32 s36, s61, 2097152
s_add_u32 s37, s36, 131072
s_waitcnt lgkmcnt(0)
v_and_or_b32 v24, v24, s57, v20
v_and_or_b32 v25, v25, s57, v21
v_and_or_b32 v26, v26, s57, v22
v_and_or_b32 v27, v27, s57, v23
buffer_store_dwordx4 v[24:27], v120, s[32:35], s36 offen sc1
v_and_or_b32 v28, v28, s57, v20
v_and_or_b32 v29, v29, s57, v21
v_and_or_b32 v30, v30, s57, v22
v_and_or_b32 v31, v31, s57, v23
s_mov_b32 exec_hi, 0
buffer_store_dwordx4 v[28:31], v120, s[32:35], s37 offen sc1
s_mov_b64 exec, -1
L_now40:
s_cmp_eq_u32 s22, 3
s_cbranch_scc1 L_final
s_cmp_lt_u32 s22, 2
s_cbranch_scc1 L_disp
v_lshrrev_b32 v8, 5, v0
v_and_b32 v9, 31, v0
v_lshlrev_b32 v9, 4, v9
v_lshl_add_u32 v9, v8, 11, v9
v_add_u32 v15, 148992, v9
s_add_u32 s37, s61, 2621440
s_add_u32 s38, s37, 131072
s_mov_b32 s46, 0x40000
L_w45:
ds_read_b32 v8, v6 offset:16
s_waitcnt lgkmcnt(0)
v_readfirstlane_b32 s43, v8
s_nop 0
s_cmp_ge_u32 s43, 4
s_cbranch_scc1 L_wd46
s_sub_u32 s46, s46, 1
s_cbranch_scc1 L_wd46
s_sleep 16
s_branch L_w45
L_wd46:
s_mov_b32 s46, 0x40000
L_w47:
ds_read_b32 v8, v6 offset:20
s_waitcnt lgkmcnt(0)
v_readfirstlane_b32 s43, v8
s_nop 0
s_cmp_ge_u32 s43, 4
s_cbranch_scc1 L_wd48
s_sub_u32 s46, s46, 1
s_cbranch_scc1 L_wd48
s_sleep 16
s_branch L_w47
L_wd48:
s_mov_b32 s46, 0x40000
L_w49:
ds_read_b32 v8, v6 offset:24
s_waitcnt lgkmcnt(0)
v_readfirstlane_b32 s43, v8
s_nop 0
s_cmp_ge_u32 s43, 4
s_cbranch_scc1 L_wd50
s_sub_u32 s46, s46, 1
s_cbranch_scc1 L_wd50
s_sleep 16
s_branch L_w49
L_wd50:
ds_read_b128 v[56:59], v15 offset:0
ds_read_b128 v[60:63], v15 offset:512
ds_read_b128 v[64:67], v15 offset:1024
ds_read_b128 v[68:71], v15 offset:1536
s_waitcnt lgkmcnt(0)
v_add_f32 v56, v56, v60
v_add_f32 v64, v64, v68
v_add_f32 v57, v57, v61
v_add_f32 v65, v65, v69
v_add_f32 v58, v58, v62
v_add_f32 v66, v66, v70
v_add_f32 v59, v59, v63
v_add_f32 v67, v67, v71
v_add_f32 v56, v56, v64
v_add_f32 v57, v57, v65
v_add_f32 v58, v58, v66
v_add_f32 v59, v59, v67
v_and_or_b32 v56, v56, s57, v20
v_and_or_b32 v57, v57, s57, v21
v_and_or_b32 v58, v58, s57, v22
v_and_or_b32 v59, v59, s57, v23
buffer_store_dwordx4 v[56:59], v120, s[32:35], s37 offen sc1
s_mov_b32 exec_hi, 0
ds_read_b128 v[72:75], v15 offset:4096
ds_read_b128 v[76:79], v15 offset:4608
ds_read_b128 v[80:83], v15 offset:5120
ds_read_b128 v[84:87], v15 offset:5632
s_waitcnt lgkmcnt(0)
v_add_f32 v72, v72, v76
v_add_f32 v80, v80, v84
v_add_f32 v73, v73, v77
v_add_f32 v81, v81, v85
v_add_f32 v74, v74, v78
v_add_f32 v82, v82, v86
v_add_f32 v75, v75, v79
v_add_f32 v83, v83, v87
v_add_f32 v72, v72, v80
v_add_f32 v73, v73, v81
v_add_f32 v74, v74, v82
v_add_f32 v75, v75, v83
v_and_or_b32 v72, v72, s57, v20
v_and_or_b32 v73, v73, s57, v21
v_and_or_b32 v74, v74, s57, v22
v_and_or_b32 v75, v75, s57, v23
buffer_store_dwordx4 v[72:75], v120, s[32:35], s38 offen sc1
s_mov_b64 exec, -1
s_mov_b32 s46, 0x40000
L_w51:
ds_read_b32 v8, v6 offset:28
s_waitcnt lgkmcnt(0)
v_readfirstlane_b32 s43, v8
s_nop 0
s_cmp_ge_u32 s43, 4
s_cbranch_scc1 L_wd52
s_sub_u32 s46, s46, 1
s_cbranch_scc1 L_wd52
s_sleep 1
s_branch L_w51
L_wd52:
s_mov_b32 exec_lo, 0
ds_read_b128 v[72:75], v15 offset:4096
ds_read_b128 v[76:79], v15 offset:4608
ds_read_b128 v[80:83], v15 offset:5120
ds_read_b128 v[84:87], v15 offset:5632
s_waitcnt lgkmcnt(0)
v_add_f32 v72, v72, v76
v_add_f32 v80, v80, v84
v_add_f32 v73, v73, v77
v_add_f32 v81, v81, v85
v_add_f32 v74, v74, v78
v_add_f32 v82, v82, v86
v_add_f32 v75, v75, v79
v_add_f32 v83, v83, v87
v_add_f32 v72, v72, v80
v_add_f32 v73, v73, v81
v_add_f32 v74, v74, v82
v_add_f32 v75, v75, v83
v_and_or_b32 v72, v72, s57, v20
v_and_or_b32 v73, v73, s57, v21
v_and_or_b32 v74, v74, s57, v22
v_and_or_b32 v75, v75, s57, v23
buffer_store_dwordx4 v[72:75], v120, s[32:35], s38 offen sc1
s_mov_b64 exec, -1
s_endpgm
L_disp:
s_lshl_b32 s36, s21, 24
s_xor_b32 s37, s69, 3
s_lshl_b32 s37, s37, 22
s_add_u32 s36, s36, s37
s_add_u32 s36, s36, 1
s_bfe_u32 s38, s20, 196608
s_lshl_b32 s38, s38, 16
s_add_u32 s37, s36, s38
s_bfe_u32 s38, s20, 65539
s_lshl_b32 s38, s38, 21
s_add_u32 s37, s37, s38
v_mov_b32 v3, 160384
s_mov_b64 exec, 1
s_add_u32 s38, s37, 557056
v_mov_b32 v8, s38
v_mov_b32 v9, 146304
ds_write_b64 v3, v[8:9] offset:0
s_add_u32 s38, s37, 1048576
v_mov_b32 v8, s38
v_mov_b32 v9, 146816
ds_write_b64 v3, v[8:9] offset:8
s_mov_b64 exec, -1
s_lshl_b32 s38, s22, 3
s_add_u32 s38, s38, 8
v_add_u32 v3, s38, v3
s_add_u32 s39, s60, 2149580800
s_lshl_b32 s44, s22, 2
s_add_u32 s44, s44, 8
L_dl:
s_mov_b32 s46, 0x40000
L_w53:
ds_read_b32 v8, v6 offset:84
s_waitcnt lgkmcnt(0)
v_readfirstlane_b32 s43, v8
s_nop 0
s_cmp_ge_u32 s43, s44
s_cbranch_scc1 L_wd54
s_sub_u32 s46, s46, 1
s_cbranch_scc1 L_wd54
s_sleep 1
s_branch L_w53
L_wd54:
s_mov_b32 s46, 0x40000
L_w55:
ds_read_b32 v8, v3 offset:0
s_waitcnt lgkmcnt(0)
v_readfirstlane_b32 s43, v8
s_nop 0
s_cmp_ge_u32 s43, 1
s_cbranch_scc1 L_wd56
s_sub_u32 s46, s46, 1
s_cbranch_scc1 L_wd56
s_sleep 1
s_branch L_w55
L_wd56:
s_cmp_eq_u32 s43, -1
s_cbranch_scc1 L_dexit
v_mov_b32 v8, 1
s_mov_b64 exec, 1
buffer_atomic_add v8, off, s[32:35], s68 sc0
s_mov_b64 exec, -1
s_waitcnt vmcnt(0)
v_readfirstlane_b32 s43, v8
s_nop 0
s_cmp_ge_u32 s43, 48
s_cbranch_scc1 L_dend
s_and_b32 s37, s43, 15
s_lshr_b32 s38, s43, 4
s_lshl_b32 s42, s37, 8
s_lshl_b32 s41, s38, 16
s_add_u32 s42, s42, s41
s_add_u32 s42, s42, s39
s_add_u32 s38, s38, 5
s_bfe_u32 s43, s37, 196608
s_lshl_b32 s43, s43, 16
s_add_u32 s41, s36, s43
s_bfe_u32 s43, s37, 65539
s_lshl_b32 s43, s43, 21
s_add_u32 s41, s41, s43
s_bfe_u32 s43, s38, 65536
s_lshl_b32 s43, s43, 15
s_add_u32 s37, s41, s43
s_bfe_u32 s43, s38, 131073
s_lshl_b32 s43, s43, 19
s_add_u32 s37, s37, s43
v_mov_b32 v8, s37
v_mov_b32 v9, s42
ds_write_b64 v3, v[8:9] offset:8
v_add_u32 v3, 16, v3
s_add_u32 s44, s44, 8
s_branch L_dl
L_dend:
v_mov_b32 v8, -1
ds_write_b32 v3, v8 offset:8
L_dexit:
s_cmp_lg_u32 s22, 0
s_cbranch_scc1 L_done
L_final:
v_lshrrev_b32 v8, 2, v0
v_and_b32 v9, 3, v0
v_lshlrev_b32 v15, 3, v9
v_lshlrev_b32 v9, 4, v9
v_lshl_add_u32 v3, v8, 8, v9
s_and_b32 s39, s22, 1
s_lshl_b32 s38, s20, 1
s_add_u32 s39, s39, s38
s_lshr_b32 s38, s39, 2
s_lshl_b32 s38, s38, 15
s_and_b32 s37, s39, 3
s_lshl_b32 s37, s37, 6
s_add_u32 s37, s37, s38
s_add_u32 s37, s37, s60
s_add_u32 s37, s37, 2621440
s_mov_b32 s46, 0x40000
L_w57:
ds_read_b32 v8, v6 offset:28
s_waitcnt lgkmcnt(0)
v_readfirstlane_b32 s43, v8
s_nop 0
s_cmp_ge_u32 s43, 4
s_cbranch_scc1 L_wd58
s_sub_u32 s46, s46, 1
s_cbranch_scc1 L_wd58
s_sleep 1
s_branch L_w57
L_wd58:
s_mov_b64 s[62:63], -1
s_mov_b32 s46, 0x8000
L_fpoll:
s_mov_b64 exec, s[62:63]
buffer_load_dwordx4 v[56:59], v3, s[32:35], s37 offen sc1
s_mov_b64 exec, -1
s_waitcnt vmcnt(0)
v_perm_b32 v8, v57, v56, s58
v_perm_b32 v9, v59, v58, s59
v_or_b32 v8, v8, v9
v_cmp_ne_u32 s[62:63], s56, v8
s_nop 0
s_bcnt1_i32_b64 s43, s[62:63]
s_cbranch_scc0 L_fdone
s_sub_u32 s46, s46, 1
s_cbranch_scc1 L_fdone
s_cmp_le_u32 s43, 64
s_cbranch_scc1 L_ffast
s_branch L_fpoll
L_ffast:
s_mov_b64 exec, s[62:63]
buffer_load_dwordx4 v[64:67], v3, s[32:35], s37 offen sc1
s_sleep 8
buffer_load_dwordx4 v[68:71], v3, s[32:35], s37 offen sc1
L_ff:
s_mov_b64 exec, -1
s_waitcnt vmcnt(1)
v_perm_b32 v8, v65, v64, s58
v_perm_b32 v9, v67, v66, s59
v_or_b32 v8, v8, v9
v_cmp_ne_u32 vcc, s56, v8
s_andn2_b64 exec, s[62:63], vcc
v_mov_b32 v56, v64
v_mov_b32 v57, v65
v_mov_b32 v58, v66
v_mov_b32 v59, v67
s_and_b64 s[62:63], s[62:63], vcc
s_cbranch_scc0 L_fdone
s_mov_b64 exec, s[62:63]
buffer_load_dwordx4 v[64:67], v3, s[32:35], s37 offen sc1
s_mov_b64 exec, -1
s_waitcnt vmcnt(1)
v_perm_b32 v8, v69, v68, s58
v_perm_b32 v9, v71, v70, s59
v_or_b32 v8, v8, v9
v_cmp_ne_u32 vcc, s56, v8
s_andn2_b64 exec, s[62:63], vcc
v_mov_b32 v56, v68
v_mov_b32 v57, v69
v_mov_b32 v58, v70
v_mov_b32 v59, v71
s_and_b64 s[62:63], s[62:63], vcc
s_cbranch_scc0 L_fdone
s_mov_b64 exec, s[62:63]
buffer_load_dwordx4 v[68:71], v3, s[32:35], s37 offen sc1
s_sub_u32 s46, s46, 1
s_cbranch_scc0 L_ff
L_fdone:
s_mov_b64 exec, -1
v_and_b32 v56, s57, v56
v_and_b32 v57, s57, v57
v_and_b32 v58, s57, v58
v_and_b32 v59, s57, v59
s_nop 1
v_add_f32_dpp v56, v56, v56 row_ror:4 row_mask:0xf bank_mask:0xf
v_add_f32_dpp v57, v57, v57 row_ror:4 row_mask:0xf bank_mask:0xf
v_add_f32_dpp v58, v58, v58 row_ror:4 row_mask:0xf bank_mask:0xf
v_add_f32_dpp v59, v59, v59 row_ror:4 row_mask:0xf bank_mask:0xf
s_nop 1
v_add_f32_dpp v56, v56, v56 row_ror:8 row_mask:0xf bank_mask:0xf
v_add_f32_dpp v57, v57, v57 row_ror:8 row_mask:0xf bank_mask:0xf
v_add_f32_dpp v58, v58, v58 row_ror:8 row_mask:0xf bank_mask:0xf
v_add_f32_dpp v59, v59, v59 row_ror:8 row_mask:0xf bank_mask:0xf
v_mov_b32 v60, v56
v_mov_b32 v61, v57
v_mov_b32 v62, v58
v_mov_b32 v63, v59
s_nop 1
v_permlane16_swap_b32 v56, v60
v_permlane16_swap_b32 v57, v61
v_permlane16_swap_b32 v58, v62
v_permlane16_swap_b32 v59, v63
v_add_f32 v56, v56, v60
v_add_f32 v57, v57, v61
v_add_f32 v58, v58, v62
v_add_f32 v59, v59, v63
v_mov_b32 v60, v56
v_mov_b32 v61, v57
v_mov_b32 v62, v58
v_mov_b32 v63, v59
s_nop 1
v_permlane32_swap_b32 v56, v60
v_permlane32_swap_b32 v57, v61
v_permlane32_swap_b32 v58, v62
v_permlane32_swap_b32 v59, v63
v_add_f32 v56, v56, v60
v_add_f32 v57, v57, v61
v_add_f32 v58, v58, v62
v_add_f32 v59, v59, v63
v_cvt_pk_bf16_f32 v56, v56, v57
v_cvt_pk_bf16_f32 v57, v58, v59
s_lshl_b32 s36, s21, 10
s_lshl_b32 s38, s39, 5
s_lshl_b32 s43, s69, 8
s_xor_b32 s38, s38, s43
s_add_u32 s36, s36, s38
s_mov_b64 exec, 15
buffer_store_dwordx2 v[56:57], v15, s[52:55], s36 offen
s_cmp_lg_u32 s39, 0
s_cbranch_scc1 L_fend
v_mov_b32 v8, s56
s_mov_b64 exec, 1
buffer_store_dword v8, off, s[32:35], s47
L_fend:
L_done:
s_endpgm
.section .rodata,"a"
.p2align 6
.amdhsa_kernel standalone__low_rank_proj_linformer__decode_kernel
  .amdhsa_next_free_vgpr 256
  .amdhsa_next_free_sgpr 100
  .amdhsa_accum_offset 256
  .amdhsa_group_segment_fixed_size 0
  .amdhsa_kernarg_size 64
  .amdhsa_user_sgpr_count 2
  .amdhsa_user_sgpr_kernarg_segment_ptr 1
  .amdhsa_system_sgpr_workgroup_id_x 1
  .amdhsa_float_denorm_mode_32 3
.end_amdhsa_kernel
```
